```python
import torch

def _softmax(x, axis=-1):
    return torch.softmax(x, dim=axis)
def _gelu(x):
    return torch.nn.functional.gelu(x, approximate="tanh")
def _silu(x):
    return torch.nn.functional.silu(x)
def _sigmoid(x):
    return torch.sigmoid(x)
def _layernorm(x, axis=-1, eps=1e-5):
    m = x.mean(dim=axis, keepdim=True)
    v = x.var(dim=axis, keepdim=True, unbiased=False)
    return (x - m) / torch.sqrt(v + eps)
def _scatter_add(tgt, idx, src, axis=0):
    return tgt.clone().index_add_(axis, idx, src)
def _segment_sum(src, seg, n):
    out = torch.zeros((n,) + src.shape[1:], dtype=src.dtype)
    return out.index_add_(0, seg, src)
def _pad(x, pw):
    flat = tuple(v for pair in reversed(pw) for v in pair)
    return torch.nn.functional.pad(x, flat)

kernel_name = 'standalone__gqa_softmax__near_ridge'

def setup_inputs():

    _w = (lambda a: (lambda t: t.to(torch.bfloat16) if t.is_floating_point() else t)(torch.as_tensor(a)))
    B, Hq, Hkv, Sq, Sk, D = 8, 32, 16, 336, 1024, 128
    return {
        "q": _w((lambda *s: torch.randn(*s, dtype=torch.bfloat16) * 0.8)(B, Hq, Sq, D)),
        "k": _w((lambda *s: torch.randn(*s, dtype=torch.bfloat16) * 0.8)(B, Hkv, Sk, D)),
        "v": _w((lambda *s: torch.randn(*s, dtype=torch.bfloat16) * 0.05)(B, Hkv, Sk, D)),
    }

def reference(q, k, v):
    B, Hq, Sq, D = q.shape
    Hkv = k.shape[1]
    rep = Hq // Hkv
    k = (lambda x, n, axis: torch.repeat_interleave(x, n, dim=axis))(k, rep, axis=1)
    v = (lambda x, n, axis: torch.repeat_interleave(x, n, dim=axis))(v, rep, axis=1)
    scale = D ** -0.5
    scores = torch.einsum("bhqd,bhkd->bhqk", q, k) * scale
    p = _softmax(scores, axis=-1)
    return torch.einsum("bhqk,bhkd->bhqd", p, v)
```

```asm
; @launch grid=(256,1,1) block=(256,1,1) lds=156288
.amdgcn_target "amdgcn-amd-amdhsa--gfx950"
.text
.globl standalone__gqa_softmax__near_ridge_kernel
.p2align 12
.p2align 8
.type standalone__gqa_softmax__near_ridge_kernel,@function
standalone__gqa_softmax__near_ridge_kernel:
    s_cmp_ge_u32 s2, 256
    s_cbranch_scc1 L_end
    s_load_dwordx8 s[4:11], s[0:1], 0
    s_getpc_b64 s[92:93]
L_pc:
    v_lshlrev_b32 v248, 6, v0
    s_and_b32 s93, s93, 0xffff
    s_mov_b32 s94, L_code_end-L_pc
    s_mov_b32 s95, 0x00020000
    s_lshr_b32 s36, s2, 3
    s_and_b32 s36, s36, 1
    s_lshl_b32 s36, s36, 14
    buffer_load_dword v254, v248, s[92:95], s36 offen offset:0
    s_and_b32 s36, s2, 7
    s_lshl_b32 s36, s36, 5
    s_lshr_b32 s37, s2, 3
    s_add_u32 s33, s36, s37
    v_lshrrev_b32 v11, 6, v0
    v_and_b32 v12, 63, v0
    v_readfirstlane_b32 s28, v11
    v_and_b32 v13, 15, v12
    v_lshrrev_b32 v14, 4, v12
    s_mul_i32 s38, s33, 86016
    s_lshr_b32 s39, s33, 1
    s_lshl_b32 s39, s39, 18
    s_mul_i32 s44, s28, 4224
    s_mov_b32 s29, s44
    s_mul_i32 s45, s28, 20480
    s_mov_b32 s34, 0x3e0293ee
    v_lshlrev_b32 v8, 12, v14
    v_lshl_add_u32 v8, v13, 4, v8
    s_lshl_b32 s40, s28, 10
    v_add_u32 v8, s40, v8
    v_lshlrev_b32 v9, 8, v13
    v_lshl_add_u32 v9, v14, 4, v9
    s_add_u32 s29, s29, 128
    s_andn2_b32 s29, s29, 255
    v_lshlrev_b32 v248, 5, v13
    v_and_b32 v248, 0xe0, v248
    v_xor_b32 v9, v248, v9
    v_add_u32 v9, s29, v9
    s_lshr_b32 s30, s33, 1
    s_and_b32 s30, s30, 7
    s_lshl_b32 s30, s30, 15
    s_add_u32 s31, s30, 16384
    s_mov_b32 s58, 33792
    s_mov_b32 s35, 33792
    s_movk_i32 s42, 1056
    v_mul_lo_u32 v11, v13, s42
    v_lshl_add_u32 v11, v14, 4, v11
    v_lshrrev_b32 v15, 2, v12
    v_mul_lo_u32 v15, v15, s42
    v_and_b32 v248, 3, v12
    v_lshl_add_u32 v15, v248, 3, v15
    v_add_u32 v15, 16896, v15
    v_and_b32 v248, 1, v14
    v_lshrrev_b32 v249, 1, v14
    v_lshlrev_b32 v10, 8, v13
    v_lshl_add_u32 v10, v248, 5, v10
    v_lshl_add_u32 v10, v249, 4, v10
    v_lshlrev_b32 v255, 4, v12
    s_add_u32 s36, s28, 0
    s_and_b32 s36, s36, 3
    s_lshr_b32 s37, s36, 1
    s_mul_i32 s37, s37, 67584
    s_and_b32 s36, s36, 1
    s_lshl_b32 s36, s36, 9
    s_add_u32 s36, s36, s37
    v_add_u32 v0, s36, v11
    v_add_u32 v4, s36, v15
    s_add_u32 s36, s28, 1
    s_and_b32 s36, s36, 3
    s_lshr_b32 s37, s36, 1
    s_mul_i32 s37, s37, 67584
    s_and_b32 s36, s36, 1
    s_lshl_b32 s36, s36, 9
    s_add_u32 s36, s36, s37
    v_add_u32 v1, s36, v11
    v_add_u32 v5, s36, v15
    s_add_u32 s36, s28, 2
    s_and_b32 s36, s36, 3
    s_lshr_b32 s37, s36, 1
    s_mul_i32 s37, s37, 67584
    s_and_b32 s36, s36, 1
    s_lshl_b32 s36, s36, 9
    s_add_u32 s36, s36, s37
    v_add_u32 v2, s36, v11
    v_add_u32 v6, s36, v15
    s_add_u32 s36, s28, 3
    s_and_b32 s36, s36, 3
    s_lshr_b32 s37, s36, 1
    s_mul_i32 s37, s37, 67584
    s_and_b32 s36, s36, 1
    s_lshl_b32 s36, s36, 9
    s_add_u32 s36, s36, s37
    v_add_u32 v3, s36, v11
    v_add_u32 v7, s36, v15
    v_lshlrev_b32 v248, 5, v14
    v_xor_b32 v14, v248, v255
    v_xor_b32 v15, 0x80, v14
    v_mov_b32 v11, 0x3f803f80
    v_and_b32 v248, 3, v12
    v_sub_u32 v248, v248, 1
    v_ashrrev_i32 v248, 31, v248
    v_and_b32 v11, v248, v11
    v_accvgpr_write_b32 a216, v11
    v_accvgpr_write_b32 a217, v11
    v_accvgpr_write_b32 a218, v11
    v_accvgpr_write_b32 a219, v11
    s_waitcnt lgkmcnt(0)
    s_add_u32 s16, s6, s39
    s_addc_u32 s17, s7, 0
    s_and_b32 s17, s17, 0xffff
    s_mov_b32 s18, 262144
    s_mov_b32 s19, 0x00020000
    s_add_u32 m0, s44, 0
    s_nop 0
    buffer_load_dwordx4 v8, s[16:19], s30 offen offset:0 lds
    s_add_u32 m0, s44, 800
    s_nop 0
    buffer_load_dwordx4 v8, s[16:19], s30 offen offset:256 lds
    s_add_u32 m0, s44, 1600
    s_nop 0
    buffer_load_dwordx4 v8, s[16:19], s30 offen offset:512 lds
    s_add_u32 m0, s44, 2400
    s_nop 0
    buffer_load_dwordx4 v8, s[16:19], s30 offen offset:768 lds
    s_add_u32 m0, s44, 67584
    s_nop 0
    buffer_load_dwordx4 v8, s[16:19], s31 offen offset:0 lds
    s_add_u32 m0, s44, 68384
    s_nop 0
    buffer_load_dwordx4 v8, s[16:19], s31 offen offset:256 lds
    s_add_u32 m0, s44, 69184
    s_nop 0
    buffer_load_dwordx4 v8, s[16:19], s31 offen offset:512 lds
    s_add_u32 m0, s44, 69984
    s_nop 0
    buffer_load_dwordx4 v8, s[16:19], s31 offen offset:768 lds
    s_add_u32 s12, s4, s38
    s_addc_u32 s13, s5, 0
    s_and_b32 s13, s13, 0xffff
    s_mov_b32 s14, 86016
    s_mov_b32 s15, 0x00020000
    s_add_u32 s46, s45, 0
    s_add_u32 m0, s29, 33792
    s_nop 0
    buffer_load_dwordx4 v14, s[12:15], s46 offen offset:0 lds
    s_add_u32 m0, s29, 33792
    s_nop 0
    buffer_load_dwordx4 v15, s[12:15], s46 offen offset:1024 lds
    s_add_u32 m0, s29, 33792
    s_nop 0
    buffer_load_dwordx4 v14, s[12:15], s46 offen offset:2048 lds
    s_add_u32 m0, s29, 33792
    s_nop 0
    buffer_load_dwordx4 v15, s[12:15], s46 offen offset:3072 lds
    s_add_u32 s20, s8, s39
    s_addc_u32 s21, s9, 0
    s_and_b32 s21, s21, 0xffff
    s_mov_b32 s22, 262144
    s_mov_b32 s23, 0x00020000
    s_add_u32 m0, s44, 16896
    s_nop 0
    buffer_load_dwordx4 v8, s[20:23], s30 offen offset:0 lds
    s_add_u32 m0, s44, 17696
    s_nop 0
    buffer_load_dwordx4 v8, s[20:23], s30 offen offset:256 lds
    s_add_u32 m0, s44, 18496
    s_nop 0
    buffer_load_dwordx4 v8, s[20:23], s30 offen offset:512 lds
    s_add_u32 m0, s44, 19296
    s_nop 0
    buffer_load_dwordx4 v8, s[20:23], s30 offen offset:768 lds
    s_add_u32 m0, s44, 84480
    s_nop 0
    buffer_load_dwordx4 v8, s[20:23], s31 offen offset:0 lds
    s_add_u32 m0, s44, 85280
    s_nop 0
    buffer_load_dwordx4 v8, s[20:23], s31 offen offset:256 lds
    s_add_u32 m0, s44, 86080
    s_nop 0
    buffer_load_dwordx4 v8, s[20:23], s31 offen offset:512 lds
    s_add_u32 m0, s44, 86880
    s_nop 0
    buffer_load_dwordx4 v8, s[20:23], s31 offen offset:768 lds
    s_add_u32 s24, s10, s38
    s_addc_u32 s25, s11, 0
    s_and_b32 s25, s25, 0xffff
    s_mov_b32 s26, 86016
    s_mov_b32 s27, 0x00020000
    s_mov_b64 vcc, -1
    s_cmp_eq_u32 s28, 0
    s_cbranch_scc1 L_pad0
    s_cmp_eq_u32 s28, 1
    s_cbranch_scc1 L_pad1
    s_cmp_eq_u32 s28, 2
    s_cbranch_scc1 L_pad2
    s_branch L_pad3
L_padret:
    s_mov_b64 vcc, 0
    s_waitcnt vmcnt(12)
    s_barrier
    ds_read_b128 a[32:35], v0 offset:0
    ds_read_b128 a[36:39], v0 offset:64
    ds_read_b128 a[40:43], v0 offset:128
    ds_read_b128 a[44:47], v0 offset:192
    ds_read_b128 a[48:51], v0 offset:256
    ds_read_b128 a[52:55], v0 offset:320
    ds_read_b128 a[56:59], v0 offset:384
    ds_read_b128 a[60:63], v0 offset:448
    s_lshl_b32 s47, s28, 10
    s_add_u32 m0, s47, 152064
    s_add_u32 s47, s47, 81920
    s_lshl_b32 s36, s28, 7
    s_and_b32 s36, s36, 128
    v_xor_b32 v248, s36, v14
    s_nop 0
    buffer_load_dwordx4 v248, s[12:15], s47 offen offset:0 lds
    s_add_u32 s30, s30, 32768
    s_and_b32 s30, s30, 262143
    s_add_u32 s31, s30, 16384
    s_add_u32 s44, s44, s58
    s_sub_u32 s58, 0, s58
    v_add_u32 v11, 33792, v9
    v_xor_b32 v248, 64, v11
    v_xor_b32 v249, 128, v11
    v_xor_b32 v250, 192, v11
    s_waitcnt vmcnt(9)
    ds_read_b128 v[16:19], v11 offset:0
    ds_read_b128 v[20:23], v248 offset:0
    ds_read_b128 v[24:27], v249 offset:0
    ds_read_b128 v[28:31], v250 offset:0
    s_waitcnt lgkmcnt(3)
    v_lshlrev_b32 v248, 16, v16
    v_and_b32 v249, 0xffff0000, v16
    v_pk_mul_f32 v[248:249], v[248:249], s[34:35] op_sel_hi:[1,0]
    v_cvt_pk_bf16_f32 v16, v248, v249
    v_lshlrev_b32 v250, 16, v17
    v_and_b32 v251, 0xffff0000, v17
    v_pk_mul_f32 v[250:251], v[250:251], s[34:35] op_sel_hi:[1,0]
    v_cvt_pk_bf16_f32 v17, v250, v251
    v_lshlrev_b32 v248, 16, v18
    v_and_b32 v249, 0xffff0000, v18
    v_pk_mul_f32 v[248:249], v[248:249], s[34:35] op_sel_hi:[1,0]
    v_cvt_pk_bf16_f32 v18, v248, v249
    v_lshlrev_b32 v250, 16, v19
    v_and_b32 v251, 0xffff0000, v19
    v_pk_mul_f32 v[250:251], v[250:251], s[34:35] op_sel_hi:[1,0]
    v_cvt_pk_bf16_f32 v19, v250, v251
    s_waitcnt lgkmcnt(2)
    v_lshlrev_b32 v248, 16, v20
    v_and_b32 v249, 0xffff0000, v20
    v_pk_mul_f32 v[248:249], v[248:249], s[34:35] op_sel_hi:[1,0]
    v_cvt_pk_bf16_f32 v20, v248, v249
    v_lshlrev_b32 v250, 16, v21
    v_and_b32 v251, 0xffff0000, v21
    v_pk_mul_f32 v[250:251], v[250:251], s[34:35] op_sel_hi:[1,0]
    v_cvt_pk_bf16_f32 v21, v250, v251
    v_lshlrev_b32 v248, 16, v22
    v_and_b32 v249, 0xffff0000, v22
    v_pk_mul_f32 v[248:249], v[248:249], s[34:35] op_sel_hi:[1,0]
    v_cvt_pk_bf16_f32 v22, v248, v249
    v_lshlrev_b32 v250, 16, v23
    v_and_b32 v251, 0xffff0000, v23
    v_pk_mul_f32 v[250:251], v[250:251], s[34:35] op_sel_hi:[1,0]
    v_cvt_pk_bf16_f32 v23, v250, v251
    s_waitcnt lgkmcnt(1)
    v_lshlrev_b32 v248, 16, v24
    v_and_b32 v249, 0xffff0000, v24
    v_pk_mul_f32 v[248:249], v[248:249], s[34:35] op_sel_hi:[1,0]
    v_cvt_pk_bf16_f32 v24, v248, v249
    v_lshlrev_b32 v250, 16, v25
    v_and_b32 v251, 0xffff0000, v25
    v_pk_mul_f32 v[250:251], v[250:251], s[34:35] op_sel_hi:[1,0]
    v_cvt_pk_bf16_f32 v25, v250, v251
    v_lshlrev_b32 v248, 16, v26
    v_and_b32 v249, 0xffff0000, v26
    v_pk_mul_f32 v[248:249], v[248:249], s[34:35] op_sel_hi:[1,0]
    v_cvt_pk_bf16_f32 v26, v248, v249
    v_lshlrev_b32 v250, 16, v27
    v_and_b32 v251, 0xffff0000, v27
    v_pk_mul_f32 v[250:251], v[250:251], s[34:35] op_sel_hi:[1,0]
    v_cvt_pk_bf16_f32 v27, v250, v251
    s_waitcnt lgkmcnt(0)
    v_lshlrev_b32 v248, 16, v28
    v_and_b32 v249, 0xffff0000, v28
    v_pk_mul_f32 v[248:249], v[248:249], s[34:35] op_sel_hi:[1,0]
    v_cvt_pk_bf16_f32 v28, v248, v249
    v_lshlrev_b32 v250, 16, v29
    v_and_b32 v251, 0xffff0000, v29
    v_pk_mul_f32 v[250:251], v[250:251], s[34:35] op_sel_hi:[1,0]
    v_cvt_pk_bf16_f32 v29, v250, v251
    v_lshlrev_b32 v248, 16, v30
    v_and_b32 v249, 0xffff0000, v30
    v_pk_mul_f32 v[248:249], v[248:249], s[34:35] op_sel_hi:[1,0]
    v_cvt_pk_bf16_f32 v30, v248, v249
    v_lshlrev_b32 v250, 16, v31
    v_and_b32 v251, 0xffff0000, v31
    v_pk_mul_f32 v[250:251], v[250:251], s[34:35] op_sel_hi:[1,0]
    v_cvt_pk_bf16_f32 v31, v250, v251
    s_nop 1
    s_waitcnt lgkmcnt(15)
    v_mfma_f32_16x16x32_bf16 v[224:227], a[32:35], v[16:19], 0
    s_add_u32 s47, s45, 4096
    s_add_u32 m0, s29, 101376
    ds_read_b128 a[64:67], v1 offset:0
    ds_read_b128 a[68:71], v1 offset:64
    ds_read_b128 a[72:75], v1 offset:128
    ds_read_b128 a[76:79], v1 offset:192
    v_mfma_f32_16x16x32_bf16 v[224:227], a[36:39], v[20:23], v[224:227]
    buffer_load_dwordx4 v14, s[12:15], s47 offen offset:0 lds
    ds_read_b128 a[80:83], v1 offset:256
    ds_read_b128 a[84:87], v1 offset:320
    ds_read_b128 a[88:91], v1 offset:384
    v_mfma_f32_16x16x32_bf16 v[224:227], a[40:43], v[24:27], v[224:227]
    ds_read_b128 a[92:95], v1 offset:448
    ds_read_b128 a[32:35], v2 offset:0
    ds_read_b128 a[36:39], v2 offset:64
    ds_read_b128 a[40:43], v2 offset:128
    v_mfma_f32_16x16x32_bf16 v[224:227], a[44:47], v[28:31], v[224:227]
    ds_read_b128 a[44:47], v2 offset:192
    v_mfma_f32_16x16x32_bf16 v[228:231], a[60:63], v[28:31], 0
    s_add_u32 m0, s29, 101376
    v_mfma_f32_16x16x32_bf16 v[228:231], a[56:59], v[24:27], v[228:231]
    buffer_load_dwordx4 v15, s[12:15], s47 offen offset:1024 lds
    v_mfma_f32_16x16x32_bf16 v[228:231], a[52:55], v[20:23], v[228:231]
    v_mfma_f32_16x16x32_bf16 v[228:231], a[48:51], v[16:19], v[228:231]
    s_waitcnt lgkmcnt(5)
    ds_read_b128 a[48:51], v2 offset:256
    ds_read_b128 a[52:55], v2 offset:320
    ds_read_b128 a[56:59], v2 offset:384
    ds_read_b128 a[60:63], v2 offset:448
    v_mfma_f32_16x16x32_bf16 v[232:235], a[64:67], v[16:19], 0
    s_add_u32 m0, s29, 101376
    ds_read_b128 a[64:67], v3 offset:0
    v_mfma_f32_16x16x32_bf16 v[232:235], a[68:71], v[20:23], v[232:235]
    buffer_load_dwordx4 v14, s[12:15], s47 offen offset:2048 lds
    ds_read_b128 a[68:71], v3 offset:64
    v_mfma_f32_16x16x32_bf16 v[232:235], a[72:75], v[24:27], v[232:235]
    ds_read_b128 a[72:75], v3 offset:128
    v_mfma_f32_16x16x32_bf16 v[232:235], a[76:79], v[28:31], v[232:235]
    s_waitcnt lgkmcnt(11)
    ds_read_b128 a[76:79], v3 offset:192
    v_exp_f32 v224, v224
    v_exp_f32 v225, v225
    v_mfma_f32_16x16x32_bf16 v[236:239], a[92:95], v[28:31], 0
    s_add_u32 m0, s29, 101376
    v_exp_f32 v226, v226
    v_exp_f32 v227, v227
    v_mfma_f32_16x16x32_bf16 v[236:239], a[88:91], v[24:27], v[236:239]
    buffer_load_dwordx4 v15, s[12:15], s47 offen offset:3072 lds
    v_cvt_pk_bf16_f32 v224, v224, v225
    v_cvt_pk_bf16_f32 v225, v226, v227
    v_mfma_f32_16x16x32_bf16 v[236:239], a[84:87], v[20:23], v[236:239]
    v_mfma_f32_16x16x32_bf16 v[236:239], a[80:83], v[16:19], v[236:239]
    ds_read_b128 a[80:83], v3 offset:256
    ds_read_b128 a[84:87], v3 offset:320
    v_exp_f32 v228, v228
    v_exp_f32 v229, v229
    v_exp_f32 v230, v230
    v_exp_f32 v231, v231
    v_cvt_pk_bf16_f32 v226, v228, v229
    v_cvt_pk_bf16_f32 v227, v230, v231
    s_waitcnt vmcnt(4)
    s_barrier
    s_waitcnt lgkmcnt(6)
    v_mfma_f32_16x16x32_bf16 v[240:243], a[32:35], v[16:19], 0
    s_add_u32 s46, s45, 8192
    s_add_u32 m0, s29, 50688
    ds_read_b64_tr_b16 a[96:97], v4 offset:0
    ds_read_b64_tr_b16 a[98:99], v4 offset:256
    v_exp_f32 v232, v232
    v_mfma_f32_16x16x32_bf16 v[240:243], a[36:39], v[20:23], v[240:243]
    buffer_load_dwordx4 v14, s[12:15], s46 offen offset:0 lds
    ds_read_b64_tr_b16 a[100:101], v4 offset:32
    v_exp_f32 v233, v233
    v_mfma_f32_16x16x32_bf16 v[240:243], a[40:43], v[24:27], v[240:243]
    ds_read_b64_tr_b16 a[102:103], v4 offset:288
    ds_read_b64_tr_b16 a[104:105], v4 offset:64
    ds_read_b64_tr_b16 a[106:107], v4 offset:320
    v_cvt_pk_bf16_f32 v232, v232, v233
    v_mfma_f32_16x16x32_bf16 v[240:243], a[44:47], v[28:31], v[240:243]
    ds_read_b64_tr_b16 a[108:109], v4 offset:96
    ds_read_b64_tr_b16 a[110:111], v4 offset:352
    v_exp_f32 v234, v234
    v_mfma_f32_16x16x32_bf16 v[244:247], a[60:63], v[28:31], 0
    s_add_u32 m0, s29, 50688
    ds_read_b64_tr_b16 a[112:113], v4 offset:128
    ds_read_b64_tr_b16 a[114:115], v4 offset:384
    v_exp_f32 v235, v235
    v_mfma_f32_16x16x32_bf16 v[244:247], a[56:59], v[24:27], v[244:247]
    buffer_load_dwordx4 v15, s[12:15], s46 offen offset:1024 lds
    ds_read_b64_tr_b16 a[116:117], v4 offset:160
    ds_read_b64_tr_b16 a[118:119], v4 offset:416
    v_cvt_pk_bf16_f32 v233, v234, v235
    v_mfma_f32_16x16x32_bf16 v[244:247], a[52:55], v[20:23], v[244:247]
    ds_read_b64_tr_b16 a[120:121], v4 offset:192
    ds_read_b64_tr_b16 a[122:123], v4 offset:448
    ds_read_b64_tr_b16 a[124:125], v4 offset:224
    ds_read_b64_tr_b16 a[126:127], v4 offset:480
    v_mfma_f32_16x16x32_bf16 v[244:247], a[48:51], v[16:19], v[244:247]
    ds_read_b128 a[88:91], v3 offset:384
    ds_read_b128 a[92:95], v3 offset:448
    v_exp_f32 v236, v236
    v_mfma_f32_16x16x32_bf16 a[192:195], a[216:219], v[224:227], 0
    s_waitcnt lgkmcnt(12)
    s_add_u32 m0, s29, 50688
    ds_read_b64_tr_b16 a[128:129], v5 offset:0
    ds_read_b64_tr_b16 a[130:131], v5 offset:256
    v_exp_f32 v237, v237
    v_mfma_f32_16x16x32_bf16 a[0:3], a[96:99], v[224:227], 0
    buffer_load_dwordx4 v14, s[12:15], s46 offen offset:2048 lds
    ds_read_b64_tr_b16 a[132:133], v5 offset:32
    ds_read_b64_tr_b16 a[134:135], v5 offset:288
    v_cvt_pk_bf16_f32 v234, v236, v237
    v_mfma_f32_16x16x32_bf16 a[4:7], a[100:103], v[224:227], 0
    ds_read_b64_tr_b16 a[136:137], v5 offset:64
    ds_read_b64_tr_b16 a[138:139], v5 offset:320
    ds_read_b64_tr_b16 a[140:141], v5 offset:96
    ds_read_b64_tr_b16 a[142:143], v5 offset:352
    v_mfma_f32_16x16x32_bf16 a[8:11], a[104:107], v[224:227], 0
    s_waitcnt lgkmcnt(14)
    ds_read_b64_tr_b16 a[144:145], v5 offset:128
    ds_read_b64_tr_b16 a[146:147], v5 offset:384
    v_exp_f32 v238, v238
    v_mfma_f32_16x16x32_bf16 a[12:15], a[108:111], v[224:227], 0
    s_add_u32 m0, s29, 50688
    ds_read_b64_tr_b16 a[148:149], v5 offset:160
    ds_read_b64_tr_b16 a[150:151], v5 offset:416
    v_exp_f32 v239, v239
    v_mfma_f32_16x16x32_bf16 a[16:19], a[112:115], v[224:227], 0
    buffer_load_dwordx4 v15, s[12:15], s46 offen offset:3072 lds
    ds_read_b64_tr_b16 a[152:153], v5 offset:192
    ds_read_b64_tr_b16 a[154:155], v5 offset:448
    v_cvt_pk_bf16_f32 v235, v238, v239
    v_mfma_f32_16x16x32_bf16 a[20:23], a[116:119], v[224:227], 0
    s_waitcnt lgkmcnt(15)
    ds_read_b64_tr_b16 a[156:157], v5 offset:224
    ds_read_b64_tr_b16 a[158:159], v5 offset:480
    v_mfma_f32_16x16x32_bf16 a[24:27], a[120:123], v[224:227], 0
    ds_read_b64_tr_b16 a[96:97], v6 offset:0
    ds_read_b64_tr_b16 a[98:99], v6 offset:256
    v_mfma_f32_16x16x32_bf16 a[28:31], a[124:127], v[224:227], 0
    s_waitcnt lgkmcnt(15)
    s_add_u32 s47, s45, 12288
    s_add_u32 m0, s29, 118272
    ds_read_b64_tr_b16 a[100:101], v6 offset:32
    ds_read_b64_tr_b16 a[102:103], v6 offset:288
    ds_read_b64_tr_b16 a[104:105], v6 offset:64
    ds_read_b64_tr_b16 a[106:107], v6 offset:320
    v_mfma_f32_16x16x32_bf16 v[224:227], a[64:67], v[16:19], 0
    buffer_load_dwordx4 v14, s[12:15], s47 offen offset:0 lds
    v_exp_f32 v240, v240
    v_mfma_f32_16x16x32_bf16 v[224:227], a[68:71], v[20:23], v[224:227]
    v_exp_f32 v241, v241
    v_mfma_f32_16x16x32_bf16 v[224:227], a[72:75], v[24:27], v[224:227]
    ds_read_b64_tr_b16 a[108:109], v6 offset:96
    v_cvt_pk_bf16_f32 v240, v240, v241
    v_mfma_f32_16x16x32_bf16 v[224:227], a[76:79], v[28:31], v[224:227]
    v_exp_f32 v242, v242
    v_mfma_f32_16x16x32_bf16 v[228:231], a[92:95], v[28:31], 0
    s_add_u32 m0, s29, 118272
    v_exp_f32 v243, v243
    v_mfma_f32_16x16x32_bf16 v[228:231], a[88:91], v[24:27], v[228:231]
    buffer_load_dwordx4 v15, s[12:15], s47 offen offset:1024 lds
    v_cvt_pk_bf16_f32 v241, v242, v243
    v_mfma_f32_16x16x32_bf16 v[228:231], a[84:87], v[20:23], v[228:231]
    ds_read_b64_tr_b16 a[110:111], v6 offset:352
    ds_read_b64_tr_b16 a[112:113], v6 offset:128
    v_mfma_f32_16x16x32_bf16 v[228:231], a[80:83], v[16:19], v[228:231]
    v_exp_f32 v244, v244
    v_mfma_f32_16x16x32_bf16 a[192:195], a[216:219], v[232:235], a[192:195]
    s_waitcnt lgkmcnt(9)
    s_add_u32 m0, s29, 118272
    v_exp_f32 v245, v245
    s_sub_u32 s36, 152064, s29
    v_add_u32 v11, s36, v9
    v_xor_b32 v248, 64, v11
    v_xor_b32 v249, 128, v11
    v_xor_b32 v250, 192, v11
    ds_read_b128 a[220:223], v11 offset:0
    ds_read_b128 a[224:227], v248 offset:0
    ds_read_b128 a[228:231], v249 offset:0
    ds_read_b128 a[232:235], v250 offset:0
    v_mfma_f32_16x16x32_bf16 a[0:3], a[128:131], v[232:235], a[0:3]
    buffer_load_dwordx4 v14, s[12:15], s47 offen offset:2048 lds
    v_cvt_pk_bf16_f32 v242, v244, v245
    v_mfma_f32_16x16x32_bf16 a[4:7], a[132:135], v[232:235], a[4:7]
    ds_read_b64_tr_b16 a[114:115], v6 offset:384
    ds_read_b64_tr_b16 a[116:117], v6 offset:160
    v_mfma_f32_16x16x32_bf16 a[8:11], a[136:139], v[232:235], a[8:11]
    v_exp_f32 v246, v246
    v_mfma_f32_16x16x32_bf16 a[12:15], a[140:143], v[232:235], a[12:15]
    s_add_u32 m0, s29, 118272
    v_exp_f32 v247, v247
    v_mfma_f32_16x16x32_bf16 a[16:19], a[144:147], v[232:235], a[16:19]
    buffer_load_dwordx4 v15, s[12:15], s47 offen offset:3072 lds
    v_cvt_pk_bf16_f32 v243, v246, v247
    v_mfma_f32_16x16x32_bf16 a[20:23], a[148:151], v[232:235], a[20:23]
    ds_read_b64_tr_b16 a[118:119], v6 offset:416
    ds_read_b64_tr_b16 a[120:121], v6 offset:192
    v_mfma_f32_16x16x32_bf16 a[24:27], a[152:155], v[232:235], a[24:27]
    ds_read_b64_tr_b16 a[122:123], v6 offset:448
    ds_read_b64_tr_b16 a[124:125], v6 offset:224
    v_mfma_f32_16x16x32_bf16 a[28:31], a[156:159], v[232:235], a[28:31]
    ds_read_b64_tr_b16 a[126:127], v6 offset:480
    ds_read_b64_tr_b16 a[128:129], v7 offset:0
    s_waitcnt lgkmcnt(11)
    v_accvgpr_read_b32 v252, a220
    v_lshlrev_b32 v248, 16, v252
    v_and_b32 v249, 0xffff0000, v252
    v_pk_mul_f32 v[248:249], v[248:249], s[34:35] op_sel_hi:[1,0]
    v_cvt_pk_bf16_f32 v252, v248, v249
    v_accvgpr_write_b32 a220, v252
    v_accvgpr_read_b32 v253, a221
    v_lshlrev_b32 v250, 16, v253
    v_and_b32 v251, 0xffff0000, v253
    v_pk_mul_f32 v[250:251], v[250:251], s[34:35] op_sel_hi:[1,0]
    v_cvt_pk_bf16_f32 v253, v250, v251
    v_accvgpr_write_b32 a221, v253
    v_accvgpr_read_b32 v252, a222
    v_lshlrev_b32 v248, 16, v252
    v_and_b32 v249, 0xffff0000, v252
    v_pk_mul_f32 v[248:249], v[248:249], s[34:35] op_sel_hi:[1,0]
    v_cvt_pk_bf16_f32 v252, v248, v249
    v_accvgpr_write_b32 a222, v252
    v_accvgpr_read_b32 v253, a223
    v_lshlrev_b32 v250, 16, v253
    v_and_b32 v251, 0xffff0000, v253
    v_pk_mul_f32 v[250:251], v[250:251], s[34:35] op_sel_hi:[1,0]
    v_cvt_pk_bf16_f32 v253, v250, v251
    v_accvgpr_write_b32 a223, v253
    s_waitcnt lgkmcnt(10)
    v_accvgpr_read_b32 v252, a224
    v_lshlrev_b32 v248, 16, v252
    v_and_b32 v249, 0xffff0000, v252
    v_pk_mul_f32 v[248:249], v[248:249], s[34:35] op_sel_hi:[1,0]
    v_cvt_pk_bf16_f32 v252, v248, v249
    v_accvgpr_write_b32 a224, v252
    v_accvgpr_read_b32 v253, a225
    v_lshlrev_b32 v250, 16, v253
    v_and_b32 v251, 0xffff0000, v253
    v_pk_mul_f32 v[250:251], v[250:251], s[34:35] op_sel_hi:[1,0]
    v_cvt_pk_bf16_f32 v253, v250, v251
    v_accvgpr_write_b32 a225, v253
    v_accvgpr_read_b32 v252, a226
    v_lshlrev_b32 v248, 16, v252
    v_and_b32 v249, 0xffff0000, v252
    v_pk_mul_f32 v[248:249], v[248:249], s[34:35] op_sel_hi:[1,0]
    v_cvt_pk_bf16_f32 v252, v248, v249
    v_accvgpr_write_b32 a226, v252
    v_accvgpr_read_b32 v253, a227
    v_lshlrev_b32 v250, 16, v253
    v_and_b32 v251, 0xffff0000, v253
    v_pk_mul_f32 v[250:251], v[250:251], s[34:35] op_sel_hi:[1,0]
    v_cvt_pk_bf16_f32 v253, v250, v251
    v_accvgpr_write_b32 a227, v253
    s_waitcnt lgkmcnt(9)
    v_accvgpr_read_b32 v252, a228
    v_lshlrev_b32 v248, 16, v252
    v_and_b32 v249, 0xffff0000, v252
    v_pk_mul_f32 v[248:249], v[248:249], s[34:35] op_sel_hi:[1,0]
    v_cvt_pk_bf16_f32 v252, v248, v249
    v_accvgpr_write_b32 a228, v252
    v_accvgpr_read_b32 v253, a229
    v_lshlrev_b32 v250, 16, v253
    v_and_b32 v251, 0xffff0000, v253
    v_pk_mul_f32 v[250:251], v[250:251], s[34:35] op_sel_hi:[1,0]
    v_cvt_pk_bf16_f32 v253, v250, v251
    v_accvgpr_write_b32 a229, v253
    v_accvgpr_read_b32 v252, a230
    v_lshlrev_b32 v248, 16, v252
    v_and_b32 v249, 0xffff0000, v252
    v_pk_mul_f32 v[248:249], v[248:249], s[34:35] op_sel_hi:[1,0]
    v_cvt_pk_bf16_f32 v252, v248, v249
    v_accvgpr_write_b32 a230, v252
    v_accvgpr_read_b32 v253, a231
    v_lshlrev_b32 v250, 16, v253
    v_and_b32 v251, 0xffff0000, v253
    v_pk_mul_f32 v[250:251], v[250:251], s[34:35] op_sel_hi:[1,0]
    v_cvt_pk_bf16_f32 v253, v250, v251
    v_accvgpr_write_b32 a231, v253
    s_waitcnt lgkmcnt(8)
    v_accvgpr_read_b32 v252, a232
    v_lshlrev_b32 v248, 16, v252
    v_and_b32 v249, 0xffff0000, v252
    v_pk_mul_f32 v[248:249], v[248:249], s[34:35] op_sel_hi:[1,0]
    v_cvt_pk_bf16_f32 v252, v248, v249
    v_accvgpr_write_b32 a232, v252
    v_accvgpr_read_b32 v253, a233
    v_lshlrev_b32 v250, 16, v253
    v_and_b32 v251, 0xffff0000, v253
    v_pk_mul_f32 v[250:251], v[250:251], s[34:35] op_sel_hi:[1,0]
    v_cvt_pk_bf16_f32 v253, v250, v251
    v_accvgpr_write_b32 a233, v253
    v_accvgpr_read_b32 v252, a234
    v_lshlrev_b32 v248, 16, v252
    v_and_b32 v249, 0xffff0000, v252
    v_pk_mul_f32 v[248:249], v[248:249], s[34:35] op_sel_hi:[1,0]
    v_cvt_pk_bf16_f32 v252, v248, v249
    v_accvgpr_write_b32 a234, v252
    v_accvgpr_read_b32 v253, a235
    v_lshlrev_b32 v250, 16, v253
    v_and_b32 v251, 0xffff0000, v253
    v_pk_mul_f32 v[250:251], v[250:251], s[34:35] op_sel_hi:[1,0]
    v_cvt_pk_bf16_f32 v253, v250, v251
    v_accvgpr_write_b32 a235, v253
    s_nop 1
    v_mfma_f32_16x16x32_bf16 v[232:235], a[64:67], a[220:223], 0
    v_exp_f32 v224, v224
    v_mfma_f32_16x16x32_bf16 v[232:235], a[68:71], a[224:227], v[232:235]
    v_exp_f32 v225, v225
    v_mfma_f32_16x16x32_bf16 v[232:235], a[72:75], a[228:231], v[232:235]
    ds_read_b64_tr_b16 a[130:131], v7 offset:256
    v_cvt_pk_bf16_f32 v224, v224, v225
    v_mfma_f32_16x16x32_bf16 v[232:235], a[76:79], a[232:235], v[232:235]
L_pad0:
    s_cbranch_vccnz L_pad4
    v_exp_f32 v226, v226
    v_mfma_f32_16x16x32_bf16 v[236:239], a[92:95], a[232:235], 0
    v_exp_f32 v227, v227
    v_mfma_f32_16x16x32_bf16 v[236:239], a[88:91], a[228:231], v[236:239]
    ds_read_b64_tr_b16 a[132:133], v7 offset:32
    v_cvt_pk_bf16_f32 v225, v226, v227
    v_mfma_f32_16x16x32_bf16 v[236:239], a[84:87], a[224:227], v[236:239]
    ds_read_b64_tr_b16 a[134:135], v7 offset:288
    ds_read_b64_tr_b16 a[136:137], v7 offset:64
    v_mfma_f32_16x16x32_bf16 v[236:239], a[80:83], a[220:223], v[236:239]
    v_exp_f32 v228, v228
    v_mfma_f32_16x16x32_bf16 a[192:195], a[216:219], v[240:243], a[192:195]
    s_waitcnt lgkmcnt(5)
    v_exp_f32 v229, v229
    v_add_u32 v11, 101376, v9
    v_xor_b32 v248, 64, v11
    v_xor_b32 v249, 128, v11
    v_xor_b32 v250, 192, v11
    s_waitcnt vmcnt(8)
    ds_read_b128 v[32:35], v11 offset:0
    ds_read_b128 v[36:39], v248 offset:0
    ds_read_b128 v[40:43], v249 offset:0
    ds_read_b128 v[44:47], v250 offset:0
    v_mfma_f32_16x16x32_bf16 a[0:3], a[96:99], v[240:243], a[0:3]
    ds_read_b64_tr_b16 a[138:139], v7 offset:320
    v_cvt_pk_bf16_f32 v226, v228, v229
    v_mfma_f32_16x16x32_bf16 a[4:7], a[100:103], v[240:243], a[4:7]
    ds_read_b64_tr_b16 a[140:141], v7 offset:96
    ds_read_b64_tr_b16 a[142:143], v7 offset:352
    v_mfma_f32_16x16x32_bf16 a[8:11], a[104:107], v[240:243], a[8:11]
    v_exp_f32 v230, v230
    v_mfma_f32_16x16x32_bf16 a[12:15], a[108:111], v[240:243], a[12:15]
    v_exp_f32 v231, v231
    v_mfma_f32_16x16x32_bf16 a[16:19], a[112:115], v[240:243], a[16:19]
    ds_read_b64_tr_b16 a[144:145], v7 offset:128
    v_cvt_pk_bf16_f32 v227, v230, v231
    v_mfma_f32_16x16x32_bf16 a[20:23], a[116:119], v[240:243], a[20:23]
    ds_read_b64_tr_b16 a[146:147], v7 offset:384
    ds_read_b64_tr_b16 a[148:149], v7 offset:160
    v_mfma_f32_16x16x32_bf16 a[24:27], a[120:123], v[240:243], a[24:27]
    ds_read_b64_tr_b16 a[150:151], v7 offset:416
    ds_read_b64_tr_b16 a[152:153], v7 offset:192
    v_mfma_f32_16x16x32_bf16 a[28:31], a[124:127], v[240:243], a[28:31]
    ds_read_b64_tr_b16 a[154:155], v7 offset:448
    ds_read_b64_tr_b16 a[156:157], v7 offset:224
    s_waitcnt lgkmcnt(13)
    v_lshlrev_b32 v248, 16, v32
    v_and_b32 v249, 0xffff0000, v32
    v_pk_mul_f32 v[248:249], v[248:249], s[34:35] op_sel_hi:[1,0]
    v_cvt_pk_bf16_f32 v32, v248, v249
    v_lshlrev_b32 v250, 16, v33
    v_and_b32 v251, 0xffff0000, v33
    v_pk_mul_f32 v[250:251], v[250:251], s[34:35] op_sel_hi:[1,0]
    v_cvt_pk_bf16_f32 v33, v250, v251
    v_lshlrev_b32 v248, 16, v34
    v_and_b32 v249, 0xffff0000, v34
    v_pk_mul_f32 v[248:249], v[248:249], s[34:35] op_sel_hi:[1,0]
    v_cvt_pk_bf16_f32 v34, v248, v249
    v_lshlrev_b32 v250, 16, v35
    v_and_b32 v251, 0xffff0000, v35
    v_pk_mul_f32 v[250:251], v[250:251], s[34:35] op_sel_hi:[1,0]
    v_cvt_pk_bf16_f32 v35, v250, v251
    s_waitcnt lgkmcnt(12)
    v_lshlrev_b32 v248, 16, v36
    v_and_b32 v249, 0xffff0000, v36
    v_pk_mul_f32 v[248:249], v[248:249], s[34:35] op_sel_hi:[1,0]
    v_cvt_pk_bf16_f32 v36, v248, v249
    v_lshlrev_b32 v250, 16, v37
    v_and_b32 v251, 0xffff0000, v37
    v_pk_mul_f32 v[250:251], v[250:251], s[34:35] op_sel_hi:[1,0]
    v_cvt_pk_bf16_f32 v37, v250, v251
    v_lshlrev_b32 v248, 16, v38
    v_and_b32 v249, 0xffff0000, v38
    v_pk_mul_f32 v[248:249], v[248:249], s[34:35] op_sel_hi:[1,0]
    v_cvt_pk_bf16_f32 v38, v248, v249
    v_lshlrev_b32 v250, 16, v39
    v_and_b32 v251, 0xffff0000, v39
    v_pk_mul_f32 v[250:251], v[250:251], s[34:35] op_sel_hi:[1,0]
    v_cvt_pk_bf16_f32 v39, v250, v251
    s_waitcnt lgkmcnt(11)
    v_lshlrev_b32 v248, 16, v40
    v_and_b32 v249, 0xffff0000, v40
    v_pk_mul_f32 v[248:249], v[248:249], s[34:35] op_sel_hi:[1,0]
    v_cvt_pk_bf16_f32 v40, v248, v249
    v_lshlrev_b32 v250, 16, v41
    v_and_b32 v251, 0xffff0000, v41
    v_pk_mul_f32 v[250:251], v[250:251], s[34:35] op_sel_hi:[1,0]
    v_cvt_pk_bf16_f32 v41, v250, v251
    v_lshlrev_b32 v248, 16, v42
    v_and_b32 v249, 0xffff0000, v42
    v_pk_mul_f32 v[248:249], v[248:249], s[34:35] op_sel_hi:[1,0]
    v_cvt_pk_bf16_f32 v42, v248, v249
    v_lshlrev_b32 v250, 16, v43
    v_and_b32 v251, 0xffff0000, v43
    v_pk_mul_f32 v[250:251], v[250:251], s[34:35] op_sel_hi:[1,0]
    v_cvt_pk_bf16_f32 v43, v250, v251
    s_waitcnt lgkmcnt(10)
    v_lshlrev_b32 v248, 16, v44
    v_and_b32 v249, 0xffff0000, v44
    v_pk_mul_f32 v[248:249], v[248:249], s[34:35] op_sel_hi:[1,0]
    v_cvt_pk_bf16_f32 v44, v248, v249
    v_lshlrev_b32 v250, 16, v45
    v_and_b32 v251, 0xffff0000, v45
    v_pk_mul_f32 v[250:251], v[250:251], s[34:35] op_sel_hi:[1,0]
    v_cvt_pk_bf16_f32 v45, v250, v251
    v_lshlrev_b32 v248, 16, v46
    v_and_b32 v249, 0xffff0000, v46
    v_pk_mul_f32 v[248:249], v[248:249], s[34:35] op_sel_hi:[1,0]
    v_cvt_pk_bf16_f32 v46, v248, v249
    v_lshlrev_b32 v250, 16, v47
    v_and_b32 v251, 0xffff0000, v47
    v_pk_mul_f32 v[250:251], v[250:251], s[34:35] op_sel_hi:[1,0]
    v_cvt_pk_bf16_f32 v47, v250, v251
    s_nop 1
    v_mfma_f32_16x16x32_bf16 v[240:243], a[32:35], v[32:35], 0
    v_exp_f32 v232, v232
    v_mfma_f32_16x16x32_bf16 v[240:243], a[36:39], v[36:39], v[240:243]
    s_add_u32 s46, s45, 16384
    s_add_u32 m0, s29, 135168
    v_exp_f32 v233, v233
    v_mfma_f32_16x16x32_bf16 v[240:243], a[40:43], v[40:43], v[240:243]
    buffer_load_dwordx4 v14, s[12:15], s46 offen offset:0 lds
    v_cvt_pk_bf16_f32 v232, v232, v233
    v_mfma_f32_16x16x32_bf16 v[240:243], a[44:47], v[44:47], v[240:243]
    v_exp_f32 v234, v234
    v_mfma_f32_16x16x32_bf16 v[244:247], a[60:63], v[44:47], 0
    s_add_u32 m0, s29, 135168
    v_exp_f32 v235, v235
    v_mfma_f32_16x16x32_bf16 v[244:247], a[56:59], v[40:43], v[244:247]
    buffer_load_dwordx4 v15, s[12:15], s46 offen offset:1024 lds
    v_cvt_pk_bf16_f32 v233, v234, v235
    v_mfma_f32_16x16x32_bf16 v[244:247], a[52:55], v[36:39], v[244:247]
    ds_read_b64_tr_b16 a[158:159], v7 offset:480
    ds_read_b128 a[32:35], v0 offset:0
    v_mfma_f32_16x16x32_bf16 v[244:247], a[48:51], v[32:35], v[244:247]
    v_exp_f32 v236, v236
    v_mfma_f32_16x16x32_bf16 a[192:195], a[216:219], v[224:227], a[192:195]
    s_waitcnt lgkmcnt(3)
    s_add_u32 m0, s29, 135168
    v_exp_f32 v237, v237
    v_mfma_f32_16x16x32_bf16 a[0:3], a[128:131], v[224:227], a[0:3]
    buffer_load_dwordx4 v14, s[12:15], s46 offen offset:2048 lds
    v_cvt_pk_bf16_f32 v234, v236, v237
    v_mfma_f32_16x16x32_bf16 a[4:7], a[132:135], v[224:227], a[4:7]
    ds_read_b128 a[36:39], v0 offset:64
    ds_read_b128 a[40:43], v0 offset:128
    v_mfma_f32_16x16x32_bf16 a[8:11], a[136:139], v[224:227], a[8:11]
    v_exp_f32 v238, v238
    v_mfma_f32_16x16x32_bf16 a[12:15], a[140:143], v[224:227], a[12:15]
    s_add_u32 m0, s29, 135168
    v_exp_f32 v239, v239
    v_mfma_f32_16x16x32_bf16 a[16:19], a[144:147], v[224:227], a[16:19]
    buffer_load_dwordx4 v15, s[12:15], s46 offen offset:3072 lds
    v_cvt_pk_bf16_f32 v235, v238, v239
    v_mfma_f32_16x16x32_bf16 a[20:23], a[148:151], v[224:227], a[20:23]
    ds_read_b128 a[44:47], v0 offset:192
    ds_read_b128 a[48:51], v0 offset:256
    v_mfma_f32_16x16x32_bf16 a[24:27], a[152:155], v[224:227], a[24:27]
    s_waitcnt lgkmcnt(5)
    ds_read_b128 a[52:55], v0 offset:320
    ds_read_b128 a[56:59], v0 offset:384
    v_mfma_f32_16x16x32_bf16 a[28:31], a[156:159], v[224:227], a[28:31]
    s_add_u32 m0, s44, 0
    ds_read_b128 a[60:63], v0 offset:448
    v_add_u32 v0, s35, v0
    v_mfma_f32_16x16x32_bf16 v[224:227], a[64:67], v[32:35], 0
    buffer_load_dwordx4 v8, s[16:19], s30 offen offset:0 lds
    v_exp_f32 v240, v240
    v_mfma_f32_16x16x32_bf16 v[224:227], a[68:71], v[36:39], v[224:227]
    v_exp_f32 v241, v241
    v_mfma_f32_16x16x32_bf16 v[224:227], a[72:75], v[40:43], v[224:227]
    ds_read_b128 a[64:67], v1 offset:0
    v_cvt_pk_bf16_f32 v240, v240, v241
    v_mfma_f32_16x16x32_bf16 v[224:227], a[76:79], v[44:47], v[224:227]
    v_exp_f32 v242, v242
    v_mfma_f32_16x16x32_bf16 v[228:231], a[92:95], v[44:47], 0
    s_add_u32 m0, s44, 800
    v_exp_f32 v243, v243
    v_mfma_f32_16x16x32_bf16 v[228:231], a[88:91], v[40:43], v[228:231]
    buffer_load_dwordx4 v8, s[16:19], s30 offen offset:256 lds
    v_cvt_pk_bf16_f32 v241, v242, v243
    v_mfma_f32_16x16x32_bf16 v[228:231], a[84:87], v[36:39], v[228:231]
    ds_read_b128 a[68:71], v1 offset:64
    ds_read_b128 a[72:75], v1 offset:128
    v_mfma_f32_16x16x32_bf16 v[228:231], a[80:83], v[32:35], v[228:231]
    v_exp_f32 v244, v244
    v_mfma_f32_16x16x32_bf16 a[212:215], a[216:219], v[232:235], 0
    s_add_u32 m0, s44, 1600
    v_exp_f32 v245, v245
    v_mfma_f32_16x16x32_bf16 a[160:163], a[128:131], v[232:235], 0
    buffer_load_dwordx4 v8, s[16:19], s30 offen offset:512 lds
    v_cvt_pk_bf16_f32 v242, v244, v245
    v_mfma_f32_16x16x32_bf16 a[164:167], a[132:135], v[232:235], 0
    ds_read_b128 a[76:79], v1 offset:192
    ds_read_b128 a[80:83], v1 offset:256
    v_mfma_f32_16x16x32_bf16 a[168:171], a[136:139], v[232:235], 0
    v_exp_f32 v246, v246
    v_mfma_f32_16x16x32_bf16 a[172:175], a[140:143], v[232:235], 0
    s_add_u32 m0, s44, 2400
    v_exp_f32 v247, v247
    v_mfma_f32_16x16x32_bf16 a[176:179], a[144:147], v[232:235], 0
    buffer_load_dwordx4 v8, s[16:19], s30 offen offset:768 lds
    v_cvt_pk_bf16_f32 v243, v246, v247
    v_mfma_f32_16x16x32_bf16 a[180:183], a[148:151], v[232:235], 0
    ds_read_b128 a[84:87], v1 offset:320
    ds_read_b128 a[88:91], v1 offset:384
    v_mfma_f32_16x16x32_bf16 a[184:187], a[152:155], v[232:235], 0
    ds_read_b128 a[92:95], v1 offset:448
    v_add_u32 v1, s35, v1
    v_mfma_f32_16x16x32_bf16 a[188:191], a[156:159], v[232:235], 0
    s_waitcnt lgkmcnt(8)
    v_mfma_f32_16x16x32_bf16 v[232:235], a[32:35], v[32:35], 0
    v_exp_f32 v224, v224
    v_mfma_f32_16x16x32_bf16 v[232:235], a[36:39], v[36:39], v[232:235]
    v_exp_f32 v225, v225
    v_mfma_f32_16x16x32_bf16 v[232:235], a[40:43], v[40:43], v[232:235]
    v_cvt_pk_bf16_f32 v224, v224, v225
    v_mfma_f32_16x16x32_bf16 v[232:235], a[44:47], v[44:47], v[232:235]
    v_exp_f32 v226, v226
    v_mfma_f32_16x16x32_bf16 v[236:239], a[60:63], v[44:47], 0
    v_exp_f32 v227, v227
    v_mfma_f32_16x16x32_bf16 v[236:239], a[56:59], v[40:43], v[236:239]
    v_cvt_pk_bf16_f32 v225, v226, v227
    v_mfma_f32_16x16x32_bf16 v[236:239], a[52:55], v[36:39], v[236:239]
    v_mfma_f32_16x16x32_bf16 v[236:239], a[48:51], v[32:35], v[236:239]
    v_exp_f32 v228, v228
    v_mfma_f32_16x16x32_bf16 a[196:199], a[216:219], v[240:243], 0
    v_exp_f32 v229, v229
    v_mfma_f32_16x16x32_bf16 v[96:99], a[96:99], v[240:243], 0
    ds_read_b64_tr_b16 a[96:97], v4 offset:0
    v_cvt_pk_bf16_f32 v226, v228, v229
    v_mfma_f32_16x16x32_bf16 v[100:103], a[100:103], v[240:243], 0
    ds_read_b64_tr_b16 a[98:99], v4 offset:256
    ds_read_b64_tr_b16 a[100:101], v4 offset:32
    v_mfma_f32_16x16x32_bf16 v[104:107], a[104:107], v[240:243], 0
    v_exp_f32 v230, v230
    v_mfma_f32_16x16x32_bf16 v[108:111], a[108:111], v[240:243], 0
    v_exp_f32 v231, v231
    v_mfma_f32_16x16x32_bf16 v[112:115], a[112:115], v[240:243], 0
    ds_read_b64_tr_b16 a[102:103], v4 offset:288
    v_cvt_pk_bf16_f32 v227, v230, v231
    v_mfma_f32_16x16x32_bf16 v[116:119], a[116:119], v[240:243], 0
    ds_read_b64_tr_b16 a[104:105], v4 offset:64
    ds_read_b64_tr_b16 a[106:107], v4 offset:320
    v_mfma_f32_16x16x32_bf16 v[120:123], a[120:123], v[240:243], 0
    ds_read_b64_tr_b16 a[108:109], v4 offset:96
    ds_read_b64_tr_b16 a[110:111], v4 offset:352
    v_mfma_f32_16x16x32_bf16 v[124:127], a[124:127], v[240:243], 0
    s_waitcnt lgkmcnt(8)
    ds_read_b64_tr_b16 a[112:113], v4 offset:128
    ds_read_b64_tr_b16 a[114:115], v4 offset:384
    v_mfma_f32_16x16x32_bf16 v[240:243], a[64:67], v[32:35], 0
    v_exp_f32 v232, v232
    v_mfma_f32_16x16x32_bf16 v[240:243], a[68:71], v[36:39], v[240:243]
    v_exp_f32 v233, v233
    v_mfma_f32_16x16x32_bf16 v[240:243], a[72:75], v[40:43], v[240:243]
    ds_read_b64_tr_b16 a[116:117], v4 offset:160
    v_cvt_pk_bf16_f32 v232, v232, v233
    v_mfma_f32_16x16x32_bf16 v[240:243], a[76:79], v[44:47], v[240:243]
    v_exp_f32 v234, v234
    v_mfma_f32_16x16x32_bf16 v[244:247], a[92:95], v[44:47], 0
    v_exp_f32 v235, v235
    v_mfma_f32_16x16x32_bf16 v[244:247], a[88:91], v[40:43], v[244:247]
    ds_read_b64_tr_b16 a[118:119], v4 offset:416
    v_cvt_pk_bf16_f32 v233, v234, v235
    v_mfma_f32_16x16x32_bf16 v[244:247], a[84:87], v[36:39], v[244:247]
    ds_read_b64_tr_b16 a[120:121], v4 offset:192
    ds_read_b64_tr_b16 a[122:123], v4 offset:448
    v_mfma_f32_16x16x32_bf16 v[244:247], a[80:83], v[32:35], v[244:247]
    v_exp_f32 v236, v236
    v_mfma_f32_16x16x32_bf16 a[196:199], a[216:219], v[224:227], a[196:199]
    v_exp_f32 v237, v237
    v_add_u32 v11, 50688, v9
    v_xor_b32 v248, 64, v11
    v_xor_b32 v249, 128, v11
    v_xor_b32 v250, 192, v11
    s_waitcnt vmcnt(12)
    ds_read_b128 v[48:51], v11 offset:0
    ds_read_b128 v[52:55], v248 offset:0
    ds_read_b128 v[56:59], v249 offset:0
    ds_read_b128 v[60:63], v250 offset:0
    v_mfma_f32_16x16x32_bf16 v[96:99], a[128:131], v[224:227], v[96:99]
    ds_read_b64_tr_b16 a[124:125], v4 offset:224
    v_cvt_pk_bf16_f32 v234, v236, v237
    v_mfma_f32_16x16x32_bf16 v[100:103], a[132:135], v[224:227], v[100:103]
    ds_read_b64_tr_b16 a[126:127], v4 offset:480
    v_add_u32 v4, s35, v4
    v_mfma_f32_16x16x32_bf16 v[104:107], a[136:139], v[224:227], v[104:107]
    v_exp_f32 v238, v238
    v_mfma_f32_16x16x32_bf16 v[108:111], a[140:143], v[224:227], v[108:111]
    v_exp_f32 v239, v239
    v_mfma_f32_16x16x32_bf16 v[112:115], a[144:147], v[224:227], v[112:115]
    ds_read_b64_tr_b16 a[128:129], v5 offset:0
    v_cvt_pk_bf16_f32 v235, v238, v239
    v_mfma_f32_16x16x32_bf16 v[116:119], a[148:151], v[224:227], v[116:119]
    ds_read_b64_tr_b16 a[130:131], v5 offset:256
    ds_read_b64_tr_b16 a[132:133], v5 offset:32
    v_mfma_f32_16x16x32_bf16 v[120:123], a[152:155], v[224:227], v[120:123]
    ds_read_b64_tr_b16 a[134:135], v5 offset:288
    ds_read_b64_tr_b16 a[136:137], v5 offset:64
    v_mfma_f32_16x16x32_bf16 v[124:127], a[156:159], v[224:227], v[124:127]
    ds_read_b64_tr_b16 a[138:139], v5 offset:320
    s_waitcnt lgkmcnt(11)
    v_lshlrev_b32 v248, 16, v48
    v_and_b32 v249, 0xffff0000, v48
    v_pk_mul_f32 v[248:249], v[248:249], s[34:35] op_sel_hi:[1,0]
    v_cvt_pk_bf16_f32 v48, v248, v249
    v_lshlrev_b32 v250, 16, v49
    v_and_b32 v251, 0xffff0000, v49
    v_pk_mul_f32 v[250:251], v[250:251], s[34:35] op_sel_hi:[1,0]
    v_cvt_pk_bf16_f32 v49, v250, v251
    v_lshlrev_b32 v248, 16, v50
    v_and_b32 v249, 0xffff0000, v50
    v_pk_mul_f32 v[248:249], v[248:249], s[34:35] op_sel_hi:[1,0]
    v_cvt_pk_bf16_f32 v50, v248, v249
    v_lshlrev_b32 v250, 16, v51
    v_and_b32 v251, 0xffff0000, v51
    v_pk_mul_f32 v[250:251], v[250:251], s[34:35] op_sel_hi:[1,0]
    v_cvt_pk_bf16_f32 v51, v250, v251
    s_waitcnt lgkmcnt(10)
    v_lshlrev_b32 v248, 16, v52
    v_and_b32 v249, 0xffff0000, v52
    v_pk_mul_f32 v[248:249], v[248:249], s[34:35] op_sel_hi:[1,0]
    v_cvt_pk_bf16_f32 v52, v248, v249
    v_lshlrev_b32 v250, 16, v53
    v_and_b32 v251, 0xffff0000, v53
    v_pk_mul_f32 v[250:251], v[250:251], s[34:35] op_sel_hi:[1,0]
    v_cvt_pk_bf16_f32 v53, v250, v251
    v_lshlrev_b32 v248, 16, v54
    v_and_b32 v249, 0xffff0000, v54
    v_pk_mul_f32 v[248:249], v[248:249], s[34:35] op_sel_hi:[1,0]
    v_cvt_pk_bf16_f32 v54, v248, v249
    v_lshlrev_b32 v250, 16, v55
    v_and_b32 v251, 0xffff0000, v55
    v_pk_mul_f32 v[250:251], v[250:251], s[34:35] op_sel_hi:[1,0]
    v_cvt_pk_bf16_f32 v55, v250, v251
    s_waitcnt lgkmcnt(9)
    v_lshlrev_b32 v248, 16, v56
    v_and_b32 v249, 0xffff0000, v56
    v_pk_mul_f32 v[248:249], v[248:249], s[34:35] op_sel_hi:[1,0]
    v_cvt_pk_bf16_f32 v56, v248, v249
    v_lshlrev_b32 v250, 16, v57
    v_and_b32 v251, 0xffff0000, v57
    v_pk_mul_f32 v[250:251], v[250:251], s[34:35] op_sel_hi:[1,0]
    v_cvt_pk_bf16_f32 v57, v250, v251
    v_lshlrev_b32 v248, 16, v58
    v_and_b32 v249, 0xffff0000, v58
    v_pk_mul_f32 v[248:249], v[248:249], s[34:35] op_sel_hi:[1,0]
    v_cvt_pk_bf16_f32 v58, v248, v249
    v_lshlrev_b32 v250, 16, v59
    v_and_b32 v251, 0xffff0000, v59
    v_pk_mul_f32 v[250:251], v[250:251], s[34:35] op_sel_hi:[1,0]
    v_cvt_pk_bf16_f32 v59, v250, v251
    s_waitcnt lgkmcnt(8)
    v_lshlrev_b32 v248, 16, v60
    v_and_b32 v249, 0xffff0000, v60
    v_pk_mul_f32 v[248:249], v[248:249], s[34:35] op_sel_hi:[1,0]
    v_cvt_pk_bf16_f32 v60, v248, v249
    v_lshlrev_b32 v250, 16, v61
    v_and_b32 v251, 0xffff0000, v61
    v_pk_mul_f32 v[250:251], v[250:251], s[34:35] op_sel_hi:[1,0]
    v_cvt_pk_bf16_f32 v61, v250, v251
    v_lshlrev_b32 v248, 16, v62
    v_and_b32 v249, 0xffff0000, v62
    v_pk_mul_f32 v[248:249], v[248:249], s[34:35] op_sel_hi:[1,0]
    v_cvt_pk_bf16_f32 v62, v248, v249
    v_lshlrev_b32 v250, 16, v63
    v_and_b32 v251, 0xffff0000, v63
    v_pk_mul_f32 v[250:251], v[250:251], s[34:35] op_sel_hi:[1,0]
    v_cvt_pk_bf16_f32 v63, v250, v251
    s_nop 1
    v_mfma_f32_16x16x32_bf16 v[224:227], a[32:35], v[48:51], 0
    v_exp_f32 v240, v240
    v_mfma_f32_16x16x32_bf16 v[224:227], a[36:39], v[52:55], v[224:227]
    s_add_u32 m0, s44, 67584
    v_exp_f32 v241, v241
    v_mfma_f32_16x16x32_bf16 v[224:227], a[40:43], v[56:59], v[224:227]
    buffer_load_dwordx4 v8, s[16:19], s31 offen offset:0 lds
    v_cvt_pk_bf16_f32 v240, v240, v241
    v_mfma_f32_16x16x32_bf16 v[224:227], a[44:47], v[60:63], v[224:227]
    v_exp_f32 v242, v242
    v_mfma_f32_16x16x32_bf16 v[228:231], a[60:63], v[60:63], 0
    s_add_u32 m0, s44, 68384
    v_exp_f32 v243, v243
    v_mfma_f32_16x16x32_bf16 v[228:231], a[56:59], v[56:59], v[228:231]
    buffer_load_dwordx4 v8, s[16:19], s31 offen offset:256 lds
    v_cvt_pk_bf16_f32 v241, v242, v243
    v_mfma_f32_16x16x32_bf16 v[228:231], a[52:55], v[52:55], v[228:231]
    ds_read_b64_tr_b16 a[140:141], v5 offset:96
    v_mfma_f32_16x16x32_bf16 v[228:231], a[48:51], v[48:51], v[228:231]
    v_exp_f32 v244, v244
    v_mfma_f32_16x16x32_bf16 a[196:199], a[216:219], v[232:235], a[196:199]
    s_waitcnt lgkmcnt(7)
    s_add_u32 m0, s44, 69184
    v_exp_f32 v245, v245
    v_mfma_f32_16x16x32_bf16 v[96:99], a[96:99], v[232:235], v[96:99]
    buffer_load_dwordx4 v8, s[16:19], s31 offen offset:512 lds
    v_cvt_pk_bf16_f32 v242, v244, v245
    v_mfma_f32_16x16x32_bf16 v[100:103], a[100:103], v[232:235], v[100:103]
    ds_read_b64_tr_b16 a[142:143], v5 offset:352
    v_mfma_f32_16x16x32_bf16 v[104:107], a[104:107], v[232:235], v[104:107]
    v_exp_f32 v246, v246
    v_mfma_f32_16x16x32_bf16 v[108:111], a[108:111], v[232:235], v[108:111]
    s_add_u32 m0, s44, 69984
    v_exp_f32 v247, v247
    v_mfma_f32_16x16x32_bf16 v[112:115], a[112:115], v[232:235], v[112:115]
    buffer_load_dwordx4 v8, s[16:19], s31 offen offset:768 lds
    v_cvt_pk_bf16_f32 v243, v246, v247
    v_mfma_f32_16x16x32_bf16 v[116:119], a[116:119], v[232:235], v[116:119]
    ds_read_b64_tr_b16 a[144:145], v5 offset:128
    v_mfma_f32_16x16x32_bf16 v[120:123], a[120:123], v[232:235], v[120:123]
    ds_read_b64_tr_b16 a[146:147], v5 offset:384
    v_mfma_f32_16x16x32_bf16 v[124:127], a[124:127], v[232:235], v[124:127]
    ds_read_b64_tr_b16 a[148:149], v5 offset:160
    v_mfma_f32_16x16x32_bf16 v[232:235], a[64:67], v[48:51], 0
    v_exp_f32 v224, v224
    v_mfma_f32_16x16x32_bf16 v[232:235], a[68:71], v[52:55], v[232:235]
    v_exp_f32 v225, v225
    v_mfma_f32_16x16x32_bf16 v[232:235], a[72:75], v[56:59], v[232:235]
    ds_read_b64_tr_b16 a[150:151], v5 offset:416
    v_cvt_pk_bf16_f32 v224, v224, v225
    v_mfma_f32_16x16x32_bf16 v[232:235], a[76:79], v[60:63], v[232:235]
    v_exp_f32 v226, v226
    v_mfma_f32_16x16x32_bf16 v[236:239], a[92:95], v[60:63], 0
    v_exp_f32 v227, v227
    v_mfma_f32_16x16x32_bf16 v[236:239], a[88:91], v[56:59], v[236:239]
    ds_read_b64_tr_b16 a[152:153], v5 offset:192
    v_cvt_pk_bf16_f32 v225, v226, v227
    v_mfma_f32_16x16x32_bf16 v[236:239], a[84:87], v[52:55], v[236:239]
    ds_read_b64_tr_b16 a[154:155], v5 offset:448
    v_mfma_f32_16x16x32_bf16 v[236:239], a[80:83], v[48:51], v[236:239]
    v_exp_f32 v228, v228
    v_mfma_f32_16x16x32_bf16 a[196:199], a[216:219], v[240:243], a[196:199]
    s_waitcnt lgkmcnt(2)
    v_exp_f32 v229, v229
    v_add_u32 v11, 118272, v9
    v_xor_b32 v248, 64, v11
    v_xor_b32 v249, 128, v11
    v_xor_b32 v250, 192, v11
    s_waitcnt vmcnt(12)
    ds_read_b128 v[64:67], v11 offset:0
    ds_read_b128 v[68:71], v248 offset:0
    ds_read_b128 v[72:75], v249 offset:0
    ds_read_b128 v[76:79], v250 offset:0
    v_mfma_f32_16x16x32_bf16 v[96:99], a[128:131], v[240:243], v[96:99]
    ds_read_b64_tr_b16 a[156:157], v5 offset:224
    v_cvt_pk_bf16_f32 v226, v228, v229
    v_mfma_f32_16x16x32_bf16 v[100:103], a[132:135], v[240:243], v[100:103]
    ds_read_b64_tr_b16 a[158:159], v5 offset:480
    v_mfma_f32_16x16x32_bf16 v[104:107], a[136:139], v[240:243], v[104:107]
    v_exp_f32 v230, v230
    v_mfma_f32_16x16x32_bf16 v[108:111], a[140:143], v[240:243], v[108:111]
    v_exp_f32 v231, v231
    v_mfma_f32_16x16x32_bf16 v[112:115], a[144:147], v[240:243], v[112:115]
    v_cvt_pk_bf16_f32 v227, v230, v231
    v_add_u32 v5, s35, v5
    v_mfma_f32_16x16x32_bf16 v[116:119], a[148:151], v[240:243], v[116:119]
    s_waitcnt lgkmcnt(6)
    v_mfma_f32_16x16x32_bf16 v[120:123], a[152:155], v[240:243], v[120:123]
    s_waitcnt lgkmcnt(0)
    v_mfma_f32_16x16x32_bf16 v[124:127], a[156:159], v[240:243], v[124:127]
    s_waitcnt lgkmcnt(15)
    v_lshlrev_b32 v248, 16, v64
    v_and_b32 v249, 0xffff0000, v64
    v_pk_mul_f32 v[248:249], v[248:249], s[34:35] op_sel_hi:[1,0]
    v_cvt_pk_bf16_f32 v64, v248, v249
    v_lshlrev_b32 v250, 16, v65
    v_and_b32 v251, 0xffff0000, v65
    v_pk_mul_f32 v[250:251], v[250:251], s[34:35] op_sel_hi:[1,0]
    v_cvt_pk_bf16_f32 v65, v250, v251
    v_lshlrev_b32 v248, 16, v66
    v_and_b32 v249, 0xffff0000, v66
    v_pk_mul_f32 v[248:249], v[248:249], s[34:35] op_sel_hi:[1,0]
    v_cvt_pk_bf16_f32 v66, v248, v249
    v_lshlrev_b32 v250, 16, v67
    v_and_b32 v251, 0xffff0000, v67
    v_pk_mul_f32 v[250:251], v[250:251], s[34:35] op_sel_hi:[1,0]
    v_cvt_pk_bf16_f32 v67, v250, v251
    s_waitcnt lgkmcnt(15)
    v_lshlrev_b32 v248, 16, v68
    v_and_b32 v249, 0xffff0000, v68
    v_pk_mul_f32 v[248:249], v[248:249], s[34:35] op_sel_hi:[1,0]
    v_cvt_pk_bf16_f32 v68, v248, v249
    v_lshlrev_b32 v250, 16, v69
    v_and_b32 v251, 0xffff0000, v69
    v_pk_mul_f32 v[250:251], v[250:251], s[34:35] op_sel_hi:[1,0]
    v_cvt_pk_bf16_f32 v69, v250, v251
    v_lshlrev_b32 v248, 16, v70
    v_and_b32 v249, 0xffff0000, v70
    v_pk_mul_f32 v[248:249], v[248:249], s[34:35] op_sel_hi:[1,0]
    v_cvt_pk_bf16_f32 v70, v248, v249
    v_lshlrev_b32 v250, 16, v71
    v_and_b32 v251, 0xffff0000, v71
    v_pk_mul_f32 v[250:251], v[250:251], s[34:35] op_sel_hi:[1,0]
    v_cvt_pk_bf16_f32 v71, v250, v251
    s_waitcnt lgkmcnt(15)
    v_lshlrev_b32 v248, 16, v72
    v_and_b32 v249, 0xffff0000, v72
    v_pk_mul_f32 v[248:249], v[248:249], s[34:35] op_sel_hi:[1,0]
    v_cvt_pk_bf16_f32 v72, v248, v249
    v_lshlrev_b32 v250, 16, v73
    v_and_b32 v251, 0xffff0000, v73
    v_pk_mul_f32 v[250:251], v[250:251], s[34:35] op_sel_hi:[1,0]
    v_cvt_pk_bf16_f32 v73, v250, v251
    v_lshlrev_b32 v248, 16, v74
    v_and_b32 v249, 0xffff0000, v74
    v_pk_mul_f32 v[248:249], v[248:249], s[34:35] op_sel_hi:[1,0]
    v_cvt_pk_bf16_f32 v74, v248, v249
    v_lshlrev_b32 v250, 16, v75
    v_and_b32 v251, 0xffff0000, v75
    v_pk_mul_f32 v[250:251], v[250:251], s[34:35] op_sel_hi:[1,0]
    v_cvt_pk_bf16_f32 v75, v250, v251
    s_waitcnt lgkmcnt(15)
    v_lshlrev_b32 v248, 16, v76
    v_and_b32 v249, 0xffff0000, v76
    v_pk_mul_f32 v[248:249], v[248:249], s[34:35] op_sel_hi:[1,0]
    v_cvt_pk_bf16_f32 v76, v248, v249
    v_lshlrev_b32 v250, 16, v77
    v_and_b32 v251, 0xffff0000, v77
    v_pk_mul_f32 v[250:251], v[250:251], s[34:35] op_sel_hi:[1,0]
    v_cvt_pk_bf16_f32 v77, v250, v251
    v_lshlrev_b32 v248, 16, v78
    v_and_b32 v249, 0xffff0000, v78
    v_pk_mul_f32 v[248:249], v[248:249], s[34:35] op_sel_hi:[1,0]
    v_cvt_pk_bf16_f32 v78, v248, v249
    v_lshlrev_b32 v250, 16, v79
    v_and_b32 v251, 0xffff0000, v79
    v_pk_mul_f32 v[250:251], v[250:251], s[34:35] op_sel_hi:[1,0]
    v_cvt_pk_bf16_f32 v79, v250, v251
    s_nop 1
    v_mfma_f32_16x16x32_bf16 v[240:243], a[32:35], v[64:67], 0
    v_exp_f32 v232, v232
    v_mfma_f32_16x16x32_bf16 v[240:243], a[36:39], v[68:71], v[240:243]
    s_add_u32 m0, s44, 16896
    v_exp_f32 v233, v233
    v_mfma_f32_16x16x32_bf16 v[240:243], a[40:43], v[72:75], v[240:243]
    buffer_load_dwordx4 v8, s[20:23], s30 offen offset:0 lds
    v_cvt_pk_bf16_f32 v232, v232, v233
    v_mfma_f32_16x16x32_bf16 v[240:243], a[44:47], v[76:79], v[240:243]
    v_exp_f32 v234, v234
    v_mfma_f32_16x16x32_bf16 v[244:247], a[60:63], v[76:79], 0
    s_add_u32 m0, s44, 17696
    v_exp_f32 v235, v235
    v_mfma_f32_16x16x32_bf16 v[244:247], a[56:59], v[72:75], v[244:247]
    buffer_load_dwordx4 v8, s[20:23], s30 offen offset:256 lds
    v_cvt_pk_bf16_f32 v233, v234, v235
    v_mfma_f32_16x16x32_bf16 v[244:247], a[52:55], v[68:71], v[244:247]
    v_mfma_f32_16x16x32_bf16 v[244:247], a[48:51], v[64:67], v[244:247]
    v_exp_f32 v236, v236
    v_mfma_f32_16x16x32_bf16 a[200:203], a[216:219], v[224:227], 0
    s_add_u32 m0, s44, 18496
    v_exp_f32 v237, v237
    v_mfma_f32_16x16x32_bf16 v[128:131], a[96:99], v[224:227], 0
    buffer_load_dwordx4 v8, s[20:23], s30 offen offset:512 lds
    v_cvt_pk_bf16_f32 v234, v236, v237
    v_mfma_f32_16x16x32_bf16 v[132:135], a[100:103], v[224:227], 0
    v_mfma_f32_16x16x32_bf16 v[136:139], a[104:107], v[224:227], 0
    v_exp_f32 v238, v238
    v_mfma_f32_16x16x32_bf16 v[140:143], a[108:111], v[224:227], 0
    s_add_u32 m0, s44, 19296
    v_exp_f32 v239, v239
    v_mfma_f32_16x16x32_bf16 v[144:147], a[112:115], v[224:227], 0
    buffer_load_dwordx4 v8, s[20:23], s30 offen offset:768 lds
    v_cvt_pk_bf16_f32 v235, v238, v239
    v_mfma_f32_16x16x32_bf16 v[148:151], a[116:119], v[224:227], 0
    v_mfma_f32_16x16x32_bf16 v[152:155], a[120:123], v[224:227], 0
    v_mfma_f32_16x16x32_bf16 v[156:159], a[124:127], v[224:227], 0
    v_mfma_f32_16x16x32_bf16 v[224:227], a[64:67], v[64:67], 0
    v_exp_f32 v240, v240
    v_mfma_f32_16x16x32_bf16 v[224:227], a[68:71], v[68:71], v[224:227]
    v_exp_f32 v241, v241
    v_mfma_f32_16x16x32_bf16 v[224:227], a[72:75], v[72:75], v[224:227]
    v_cvt_pk_bf16_f32 v240, v240, v241
    v_mfma_f32_16x16x32_bf16 v[224:227], a[76:79], v[76:79], v[224:227]
    v_exp_f32 v242, v242
    v_mfma_f32_16x16x32_bf16 v[228:231], a[92:95], v[76:79], 0
    v_exp_f32 v243, v243
    v_mfma_f32_16x16x32_bf16 v[228:231], a[88:91], v[72:75], v[228:231]
    v_cvt_pk_bf16_f32 v241, v242, v243
    v_mfma_f32_16x16x32_bf16 v[228:231], a[84:87], v[68:71], v[228:231]
    v_mfma_f32_16x16x32_bf16 v[228:231], a[80:83], v[64:67], v[228:231]
    v_exp_f32 v244, v244
    v_mfma_f32_16x16x32_bf16 a[200:203], a[216:219], v[232:235], a[200:203]
    v_exp_f32 v245, v245
    v_add_u32 v11, 135168, v9
    v_xor_b32 v248, 64, v11
    v_xor_b32 v249, 128, v11
    v_xor_b32 v250, 192, v11
    s_waitcnt vmcnt(12)
    ds_read_b128 v[80:83], v11 offset:0
    ds_read_b128 v[84:87], v248 offset:0
L_pad1:
    s_cbranch_vccnz L_pad5
    ds_read_b128 v[88:91], v249 offset:0
    ds_read_b128 v[92:95], v250 offset:0
    v_mfma_f32_16x16x32_bf16 v[128:131], a[128:131], v[232:235], v[128:131]
    v_cvt_pk_bf16_f32 v242, v244, v245
    v_mfma_f32_16x16x32_bf16 v[132:135], a[132:135], v[232:235], v[132:135]
    v_mfma_f32_16x16x32_bf16 v[136:139], a[136:139], v[232:235], v[136:139]
    v_exp_f32 v246, v246
    v_mfma_f32_16x16x32_bf16 v[140:143], a[140:143], v[232:235], v[140:143]
    v_exp_f32 v247, v247
    v_mfma_f32_16x16x32_bf16 v[144:147], a[144:147], v[232:235], v[144:147]
    v_cvt_pk_bf16_f32 v243, v246, v247
    v_mfma_f32_16x16x32_bf16 v[148:151], a[148:151], v[232:235], v[148:151]
    v_mfma_f32_16x16x32_bf16 v[152:155], a[152:155], v[232:235], v[152:155]
    v_mfma_f32_16x16x32_bf16 v[156:159], a[156:159], v[232:235], v[156:159]
    s_waitcnt lgkmcnt(3)
    v_lshlrev_b32 v248, 16, v80
    v_and_b32 v249, 0xffff0000, v80
    v_pk_mul_f32 v[248:249], v[248:249], s[34:35] op_sel_hi:[1,0]
    v_cvt_pk_bf16_f32 v80, v248, v249
    v_lshlrev_b32 v250, 16, v81
    v_and_b32 v251, 0xffff0000, v81
    v_pk_mul_f32 v[250:251], v[250:251], s[34:35] op_sel_hi:[1,0]
    v_cvt_pk_bf16_f32 v81, v250, v251
    v_lshlrev_b32 v248, 16, v82
    v_and_b32 v249, 0xffff0000, v82
    v_pk_mul_f32 v[248:249], v[248:249], s[34:35] op_sel_hi:[1,0]
    v_cvt_pk_bf16_f32 v82, v248, v249
    v_lshlrev_b32 v250, 16, v83
    v_and_b32 v251, 0xffff0000, v83
    v_pk_mul_f32 v[250:251], v[250:251], s[34:35] op_sel_hi:[1,0]
    v_cvt_pk_bf16_f32 v83, v250, v251
    s_waitcnt lgkmcnt(2)
    v_lshlrev_b32 v248, 16, v84
    v_and_b32 v249, 0xffff0000, v84
    v_pk_mul_f32 v[248:249], v[248:249], s[34:35] op_sel_hi:[1,0]
    v_cvt_pk_bf16_f32 v84, v248, v249
    v_lshlrev_b32 v250, 16, v85
    v_and_b32 v251, 0xffff0000, v85
    v_pk_mul_f32 v[250:251], v[250:251], s[34:35] op_sel_hi:[1,0]
    v_cvt_pk_bf16_f32 v85, v250, v251
    v_lshlrev_b32 v248, 16, v86
    v_and_b32 v249, 0xffff0000, v86
    v_pk_mul_f32 v[248:249], v[248:249], s[34:35] op_sel_hi:[1,0]
    v_cvt_pk_bf16_f32 v86, v248, v249
    v_lshlrev_b32 v250, 16, v87
    v_and_b32 v251, 0xffff0000, v87
    v_pk_mul_f32 v[250:251], v[250:251], s[34:35] op_sel_hi:[1,0]
    v_cvt_pk_bf16_f32 v87, v250, v251
    s_waitcnt lgkmcnt(1)
    v_lshlrev_b32 v248, 16, v88
    v_and_b32 v249, 0xffff0000, v88
    v_pk_mul_f32 v[248:249], v[248:249], s[34:35] op_sel_hi:[1,0]
    v_cvt_pk_bf16_f32 v88, v248, v249
    v_lshlrev_b32 v250, 16, v89
    v_and_b32 v251, 0xffff0000, v89
    v_pk_mul_f32 v[250:251], v[250:251], s[34:35] op_sel_hi:[1,0]
    v_cvt_pk_bf16_f32 v89, v250, v251
    v_lshlrev_b32 v248, 16, v90
    v_and_b32 v249, 0xffff0000, v90
    v_pk_mul_f32 v[248:249], v[248:249], s[34:35] op_sel_hi:[1,0]
    v_cvt_pk_bf16_f32 v90, v248, v249
    v_lshlrev_b32 v250, 16, v91
    v_and_b32 v251, 0xffff0000, v91
    v_pk_mul_f32 v[250:251], v[250:251], s[34:35] op_sel_hi:[1,0]
    v_cvt_pk_bf16_f32 v91, v250, v251
    s_waitcnt lgkmcnt(0)
    v_lshlrev_b32 v248, 16, v92
    v_and_b32 v249, 0xffff0000, v92
    v_pk_mul_f32 v[248:249], v[248:249], s[34:35] op_sel_hi:[1,0]
    v_cvt_pk_bf16_f32 v92, v248, v249
    v_lshlrev_b32 v250, 16, v93
    v_and_b32 v251, 0xffff0000, v93
    v_pk_mul_f32 v[250:251], v[250:251], s[34:35] op_sel_hi:[1,0]
    v_cvt_pk_bf16_f32 v93, v250, v251
    v_lshlrev_b32 v248, 16, v94
    v_and_b32 v249, 0xffff0000, v94
    v_pk_mul_f32 v[248:249], v[248:249], s[34:35] op_sel_hi:[1,0]
    v_cvt_pk_bf16_f32 v94, v248, v249
    v_lshlrev_b32 v250, 16, v95
    v_and_b32 v251, 0xffff0000, v95
    v_pk_mul_f32 v[250:251], v[250:251], s[34:35] op_sel_hi:[1,0]
    v_cvt_pk_bf16_f32 v95, v250, v251
    s_nop 1
    v_mfma_f32_16x16x32_bf16 v[232:235], a[32:35], v[80:83], 0
    v_exp_f32 v224, v224
    v_mfma_f32_16x16x32_bf16 v[232:235], a[36:39], v[84:87], v[232:235]
    s_add_u32 m0, s44, 84480
    v_exp_f32 v225, v225
    v_mfma_f32_16x16x32_bf16 v[232:235], a[40:43], v[88:91], v[232:235]
    buffer_load_dwordx4 v8, s[20:23], s31 offen offset:0 lds
    v_cvt_pk_bf16_f32 v224, v224, v225
    v_mfma_f32_16x16x32_bf16 v[232:235], a[44:47], v[92:95], v[232:235]
    v_exp_f32 v226, v226
    v_mfma_f32_16x16x32_bf16 v[236:239], a[60:63], v[92:95], 0
    s_add_u32 m0, s44, 85280
    v_exp_f32 v227, v227
    v_mfma_f32_16x16x32_bf16 v[236:239], a[56:59], v[88:91], v[236:239]
    buffer_load_dwordx4 v8, s[20:23], s31 offen offset:256 lds
    v_cvt_pk_bf16_f32 v225, v226, v227
    v_mfma_f32_16x16x32_bf16 v[236:239], a[52:55], v[84:87], v[236:239]
    ds_read_b128 a[32:35], v2 offset:0
    ds_read_b128 a[36:39], v2 offset:64
    v_mfma_f32_16x16x32_bf16 v[236:239], a[48:51], v[80:83], v[236:239]
    v_exp_f32 v228, v228
    v_mfma_f32_16x16x32_bf16 a[204:207], a[216:219], v[240:243], 0
    s_add_u32 m0, s44, 86080
    v_exp_f32 v229, v229
    v_mfma_f32_16x16x32_bf16 v[160:163], a[96:99], v[240:243], 0
    buffer_load_dwordx4 v8, s[20:23], s31 offen offset:512 lds
    v_cvt_pk_bf16_f32 v226, v228, v229
    v_mfma_f32_16x16x32_bf16 v[164:167], a[100:103], v[240:243], 0
    ds_read_b128 a[40:43], v2 offset:128
    ds_read_b128 a[44:47], v2 offset:192
    v_mfma_f32_16x16x32_bf16 v[168:171], a[104:107], v[240:243], 0
    v_exp_f32 v230, v230
    v_mfma_f32_16x16x32_bf16 v[172:175], a[108:111], v[240:243], 0
    s_add_u32 m0, s44, 86880
    v_exp_f32 v231, v231
    v_mfma_f32_16x16x32_bf16 v[176:179], a[112:115], v[240:243], 0
    buffer_load_dwordx4 v8, s[20:23], s31 offen offset:768 lds
    v_cvt_pk_bf16_f32 v227, v230, v231
    v_mfma_f32_16x16x32_bf16 v[180:183], a[116:119], v[240:243], 0
    ds_read_b128 a[48:51], v2 offset:256
    ds_read_b128 a[52:55], v2 offset:320
    v_mfma_f32_16x16x32_bf16 v[184:187], a[120:123], v[240:243], 0
    ds_read_b128 a[56:59], v2 offset:384
    ds_read_b128 a[60:63], v2 offset:448
    v_mfma_f32_16x16x32_bf16 v[188:191], a[124:127], v[240:243], 0
    v_add_u32 v2, s35, v2
    v_mfma_f32_16x16x32_bf16 v[240:243], a[64:67], v[80:83], 0
    v_exp_f32 v232, v232
    v_mfma_f32_16x16x32_bf16 v[240:243], a[68:71], v[84:87], v[240:243]
    v_exp_f32 v233, v233
    v_mfma_f32_16x16x32_bf16 v[240:243], a[72:75], v[88:91], v[240:243]
    ds_read_b128 a[64:67], v3 offset:0
    v_cvt_pk_bf16_f32 v232, v232, v233
    v_mfma_f32_16x16x32_bf16 v[240:243], a[76:79], v[92:95], v[240:243]
    v_exp_f32 v234, v234
    v_mfma_f32_16x16x32_bf16 v[244:247], a[92:95], v[92:95], 0
    v_exp_f32 v235, v235
    v_mfma_f32_16x16x32_bf16 v[244:247], a[88:91], v[88:91], v[244:247]
    ds_read_b128 a[68:71], v3 offset:64
    v_cvt_pk_bf16_f32 v233, v234, v235
    v_mfma_f32_16x16x32_bf16 v[244:247], a[84:87], v[84:87], v[244:247]
    ds_read_b128 a[72:75], v3 offset:128
    ds_read_b128 a[76:79], v3 offset:192
    v_mfma_f32_16x16x32_bf16 v[244:247], a[80:83], v[80:83], v[244:247]
    v_exp_f32 v236, v236
    v_mfma_f32_16x16x32_bf16 a[204:207], a[216:219], v[224:227], a[204:207]
    v_exp_f32 v237, v237
    v_mfma_f32_16x16x32_bf16 v[160:163], a[128:131], v[224:227], v[160:163]
    ds_read_b128 a[80:83], v3 offset:256
    v_cvt_pk_bf16_f32 v234, v236, v237
    v_mfma_f32_16x16x32_bf16 v[164:167], a[132:135], v[224:227], v[164:167]
    ds_read_b128 a[84:87], v3 offset:320
    ds_read_b128 a[88:91], v3 offset:384
    v_mfma_f32_16x16x32_bf16 v[168:171], a[136:139], v[224:227], v[168:171]
    v_exp_f32 v238, v238
    v_mfma_f32_16x16x32_bf16 v[172:175], a[140:143], v[224:227], v[172:175]
    v_exp_f32 v239, v239
    v_mfma_f32_16x16x32_bf16 v[176:179], a[144:147], v[224:227], v[176:179]
    ds_read_b128 a[92:95], v3 offset:448
    v_cvt_pk_bf16_f32 v235, v238, v239
    v_mfma_f32_16x16x32_bf16 v[180:183], a[148:151], v[224:227], v[180:183]
    v_add_u32 v3, s35, v3
    v_mfma_f32_16x16x32_bf16 v[184:187], a[152:155], v[224:227], v[184:187]
    v_mfma_f32_16x16x32_bf16 v[188:191], a[156:159], v[224:227], v[188:191]
    s_waitcnt lgkmcnt(8)
    v_mfma_f32_16x16x32_bf16 v[224:227], a[32:35], v[48:51], 0
    v_exp_f32 v240, v240
    v_mfma_f32_16x16x32_bf16 v[224:227], a[36:39], v[52:55], v[224:227]
    v_exp_f32 v241, v241
    v_mfma_f32_16x16x32_bf16 v[224:227], a[40:43], v[56:59], v[224:227]
    v_cvt_pk_bf16_f32 v240, v240, v241
    v_mfma_f32_16x16x32_bf16 v[224:227], a[44:47], v[60:63], v[224:227]
    v_exp_f32 v242, v242
    v_mfma_f32_16x16x32_bf16 v[228:231], a[60:63], v[60:63], 0
    v_exp_f32 v243, v243
    v_mfma_f32_16x16x32_bf16 v[228:231], a[56:59], v[56:59], v[228:231]
    v_cvt_pk_bf16_f32 v241, v242, v243
    v_mfma_f32_16x16x32_bf16 v[228:231], a[52:55], v[52:55], v[228:231]
    v_mfma_f32_16x16x32_bf16 v[228:231], a[48:51], v[48:51], v[228:231]
    v_exp_f32 v244, v244
    v_mfma_f32_16x16x32_bf16 a[208:211], a[216:219], v[232:235], 0
    v_exp_f32 v245, v245
    v_mfma_f32_16x16x32_bf16 v[192:195], a[96:99], v[232:235], 0
    ds_read_b64_tr_b16 a[96:97], v6 offset:0
    v_cvt_pk_bf16_f32 v242, v244, v245
    v_mfma_f32_16x16x32_bf16 v[196:199], a[100:103], v[232:235], 0
    ds_read_b64_tr_b16 a[98:99], v6 offset:256
    ds_read_b64_tr_b16 a[100:101], v6 offset:32
    v_mfma_f32_16x16x32_bf16 v[200:203], a[104:107], v[232:235], 0
    v_exp_f32 v246, v246
    v_mfma_f32_16x16x32_bf16 v[204:207], a[108:111], v[232:235], 0
    v_exp_f32 v247, v247
    v_mfma_f32_16x16x32_bf16 v[208:211], a[112:115], v[232:235], 0
    ds_read_b64_tr_b16 a[102:103], v6 offset:288
    v_cvt_pk_bf16_f32 v243, v246, v247
    v_mfma_f32_16x16x32_bf16 v[212:215], a[116:119], v[232:235], 0
    ds_read_b64_tr_b16 a[104:105], v6 offset:64
    ds_read_b64_tr_b16 a[106:107], v6 offset:320
    v_mfma_f32_16x16x32_bf16 v[216:219], a[120:123], v[232:235], 0
    ds_read_b64_tr_b16 a[108:109], v6 offset:96
    ds_read_b64_tr_b16 a[110:111], v6 offset:352
    v_mfma_f32_16x16x32_bf16 v[220:223], a[124:127], v[232:235], 0
    ds_read_b64_tr_b16 a[112:113], v6 offset:128
    ds_read_b64_tr_b16 a[114:115], v6 offset:384
    v_mfma_f32_16x16x32_bf16 v[232:235], a[32:35], v[64:67], 0
    v_exp_f32 v224, v224
    v_mfma_f32_16x16x32_bf16 v[232:235], a[36:39], v[68:71], v[232:235]
    v_exp_f32 v225, v225
    v_mfma_f32_16x16x32_bf16 v[232:235], a[40:43], v[72:75], v[232:235]
    ds_read_b64_tr_b16 a[116:117], v6 offset:160
    v_cvt_pk_bf16_f32 v224, v224, v225
    v_mfma_f32_16x16x32_bf16 v[232:235], a[44:47], v[76:79], v[232:235]
    v_exp_f32 v226, v226
    v_mfma_f32_16x16x32_bf16 v[236:239], a[60:63], v[76:79], 0
    v_exp_f32 v227, v227
    v_mfma_f32_16x16x32_bf16 v[236:239], a[56:59], v[72:75], v[236:239]
    ds_read_b64_tr_b16 a[118:119], v6 offset:416
    v_cvt_pk_bf16_f32 v225, v226, v227
    v_mfma_f32_16x16x32_bf16 v[236:239], a[52:55], v[68:71], v[236:239]
    ds_read_b64_tr_b16 a[120:121], v6 offset:192
    ds_read_b64_tr_b16 a[122:123], v6 offset:448
    v_mfma_f32_16x16x32_bf16 v[236:239], a[48:51], v[64:67], v[236:239]
    v_exp_f32 v228, v228
    v_mfma_f32_16x16x32_bf16 a[208:211], a[216:219], v[240:243], a[208:211]
    v_exp_f32 v229, v229
    v_mfma_f32_16x16x32_bf16 v[192:195], a[128:131], v[240:243], v[192:195]
    ds_read_b64_tr_b16 a[124:125], v6 offset:224
    v_cvt_pk_bf16_f32 v226, v228, v229
    v_mfma_f32_16x16x32_bf16 v[196:199], a[132:135], v[240:243], v[196:199]
    ds_read_b64_tr_b16 a[126:127], v6 offset:480
    v_add_u32 v6, s35, v6
    v_mfma_f32_16x16x32_bf16 v[200:203], a[136:139], v[240:243], v[200:203]
    v_exp_f32 v230, v230
    v_mfma_f32_16x16x32_bf16 v[204:207], a[140:143], v[240:243], v[204:207]
    v_exp_f32 v231, v231
    v_mfma_f32_16x16x32_bf16 v[208:211], a[144:147], v[240:243], v[208:211]
    ds_read_b64_tr_b16 a[128:129], v7 offset:0
    v_cvt_pk_bf16_f32 v227, v230, v231
    v_mfma_f32_16x16x32_bf16 v[212:215], a[148:151], v[240:243], v[212:215]
    ds_read_b64_tr_b16 a[130:131], v7 offset:256
    ds_read_b64_tr_b16 a[132:133], v7 offset:32
    v_mfma_f32_16x16x32_bf16 v[216:219], a[152:155], v[240:243], v[216:219]
    ds_read_b64_tr_b16 a[134:135], v7 offset:288
    ds_read_b64_tr_b16 a[136:137], v7 offset:64
    v_mfma_f32_16x16x32_bf16 v[220:223], a[156:159], v[240:243], v[220:223]
    ds_read_b64_tr_b16 a[138:139], v7 offset:320
    ds_read_b64_tr_b16 a[140:141], v7 offset:96
    v_mfma_f32_16x16x32_bf16 v[240:243], a[32:35], v[80:83], 0
    v_exp_f32 v232, v232
    v_mfma_f32_16x16x32_bf16 v[240:243], a[36:39], v[84:87], v[240:243]
    v_exp_f32 v233, v233
    v_mfma_f32_16x16x32_bf16 v[240:243], a[40:43], v[88:91], v[240:243]
    ds_read_b64_tr_b16 a[142:143], v7 offset:352
    v_cvt_pk_bf16_f32 v232, v232, v233
    v_mfma_f32_16x16x32_bf16 v[240:243], a[44:47], v[92:95], v[240:243]
    v_exp_f32 v234, v234
    v_mfma_f32_16x16x32_bf16 v[244:247], a[60:63], v[92:95], 0
    v_exp_f32 v235, v235
    v_mfma_f32_16x16x32_bf16 v[244:247], a[56:59], v[88:91], v[244:247]
    ds_read_b64_tr_b16 a[144:145], v7 offset:128
    v_cvt_pk_bf16_f32 v233, v234, v235
    v_mfma_f32_16x16x32_bf16 v[244:247], a[52:55], v[84:87], v[244:247]
    ds_read_b64_tr_b16 a[146:147], v7 offset:384
    ds_read_b64_tr_b16 a[148:149], v7 offset:160
    v_mfma_f32_16x16x32_bf16 v[244:247], a[48:51], v[80:83], v[244:247]
    v_exp_f32 v236, v236
    v_mfma_f32_16x16x32_bf16 a[200:203], a[216:219], v[224:227], a[200:203]
    s_waitcnt lgkmcnt(11)
    v_exp_f32 v237, v237
    v_mfma_f32_16x16x32_bf16 v[128:131], a[96:99], v[224:227], v[128:131]
    ds_read_b64_tr_b16 a[150:151], v7 offset:416
    v_cvt_pk_bf16_f32 v234, v236, v237
    v_mfma_f32_16x16x32_bf16 v[132:135], a[100:103], v[224:227], v[132:135]
    ds_read_b64_tr_b16 a[152:153], v7 offset:192
    v_mfma_f32_16x16x32_bf16 v[136:139], a[104:107], v[224:227], v[136:139]
    v_exp_f32 v238, v238
    v_mfma_f32_16x16x32_bf16 v[140:143], a[108:111], v[224:227], v[140:143]
    v_exp_f32 v239, v239
    v_mfma_f32_16x16x32_bf16 v[144:147], a[112:115], v[224:227], v[144:147]
    ds_read_b64_tr_b16 a[154:155], v7 offset:448
    v_cvt_pk_bf16_f32 v235, v238, v239
    v_mfma_f32_16x16x32_bf16 v[148:151], a[116:119], v[224:227], v[148:151]
    ds_read_b64_tr_b16 a[156:157], v7 offset:224
    v_mfma_f32_16x16x32_bf16 v[152:155], a[120:123], v[224:227], v[152:155]
    ds_read_b64_tr_b16 a[158:159], v7 offset:480
    v_mfma_f32_16x16x32_bf16 v[156:159], a[124:127], v[224:227], v[156:159]
    s_waitcnt lgkmcnt(15)
    v_add_u32 v7, s35, v7
    v_mfma_f32_16x16x32_bf16 v[224:227], a[64:67], v[48:51], 0
    v_exp_f32 v240, v240
    v_mfma_f32_16x16x32_bf16 v[224:227], a[68:71], v[52:55], v[224:227]
    v_exp_f32 v241, v241
    v_mfma_f32_16x16x32_bf16 v[224:227], a[72:75], v[56:59], v[224:227]
    v_cvt_pk_bf16_f32 v240, v240, v241
    v_mfma_f32_16x16x32_bf16 v[224:227], a[76:79], v[60:63], v[224:227]
    v_exp_f32 v242, v242
    v_mfma_f32_16x16x32_bf16 v[228:231], a[92:95], v[60:63], 0
    v_exp_f32 v243, v243
    v_mfma_f32_16x16x32_bf16 v[228:231], a[88:91], v[56:59], v[228:231]
    v_cvt_pk_bf16_f32 v241, v242, v243
    v_mfma_f32_16x16x32_bf16 v[228:231], a[84:87], v[52:55], v[228:231]
    v_mfma_f32_16x16x32_bf16 v[228:231], a[80:83], v[48:51], v[228:231]
    v_exp_f32 v244, v244
    v_mfma_f32_16x16x32_bf16 a[204:207], a[216:219], v[232:235], a[204:207]
    v_exp_f32 v245, v245
    v_mfma_f32_16x16x32_bf16 v[160:163], a[96:99], v[232:235], v[160:163]
    v_cvt_pk_bf16_f32 v242, v244, v245
    v_mfma_f32_16x16x32_bf16 v[164:167], a[100:103], v[232:235], v[164:167]
    v_mfma_f32_16x16x32_bf16 v[168:171], a[104:107], v[232:235], v[168:171]
    v_exp_f32 v246, v246
    v_mfma_f32_16x16x32_bf16 v[172:175], a[108:111], v[232:235], v[172:175]
    v_exp_f32 v247, v247
    v_mfma_f32_16x16x32_bf16 v[176:179], a[112:115], v[232:235], v[176:179]
    v_cvt_pk_bf16_f32 v243, v246, v247
    v_mfma_f32_16x16x32_bf16 v[180:183], a[116:119], v[232:235], v[180:183]
    v_mfma_f32_16x16x32_bf16 v[184:187], a[120:123], v[232:235], v[184:187]
    v_mfma_f32_16x16x32_bf16 v[188:191], a[124:127], v[232:235], v[188:191]
    s_waitcnt vmcnt(0)
    s_waitcnt lgkmcnt(0)
    s_barrier
    s_add_u32 s30, s30, 32768
    s_and_b32 s30, s30, 262143
    s_add_u32 s31, s30, 16384
    s_add_u32 s44, s44, s58
    s_sub_u32 s58, 0, s58
    v_mfma_f32_16x16x32_bf16 v[232:235], a[64:67], v[64:67], 0
    v_exp_f32 v224, v224
    v_mfma_f32_16x16x32_bf16 v[232:235], a[68:71], v[68:71], v[232:235]
    s_add_u32 m0, s44, 0
    v_exp_f32 v225, v225
    v_mfma_f32_16x16x32_bf16 v[232:235], a[72:75], v[72:75], v[232:235]
    buffer_load_dwordx4 v8, s[16:19], s30 offen offset:0 lds
    v_cvt_pk_bf16_f32 v224, v224, v225
    v_mfma_f32_16x16x32_bf16 v[232:235], a[76:79], v[76:79], v[232:235]
    v_exp_f32 v226, v226
    v_mfma_f32_16x16x32_bf16 v[236:239], a[92:95], v[76:79], 0
    v_exp_f32 v227, v227
    v_mfma_f32_16x16x32_bf16 v[236:239], a[88:91], v[72:75], v[236:239]
    ds_read_b128 a[32:35], v0 offset:0
    v_cvt_pk_bf16_f32 v225, v226, v227
    v_mfma_f32_16x16x32_bf16 v[236:239], a[84:87], v[68:71], v[236:239]
    ds_read_b128 a[36:39], v0 offset:64
    ds_read_b128 a[40:43], v0 offset:128
    v_mfma_f32_16x16x32_bf16 v[236:239], a[80:83], v[64:67], v[236:239]
    v_exp_f32 v228, v228
    v_mfma_f32_16x16x32_bf16 a[208:211], a[216:219], v[240:243], a[208:211]
    s_add_u32 m0, s44, 800
    v_exp_f32 v229, v229
    v_mfma_f32_16x16x32_bf16 v[192:195], a[96:99], v[240:243], v[192:195]
    buffer_load_dwordx4 v8, s[16:19], s30 offen offset:256 lds
    v_cvt_pk_bf16_f32 v226, v228, v229
    v_mfma_f32_16x16x32_bf16 v[196:199], a[100:103], v[240:243], v[196:199]
    ds_read_b64_tr_b16 a[96:97], v4 offset:0
    ds_read_b64_tr_b16 a[98:99], v4 offset:256
    v_mfma_f32_16x16x32_bf16 v[200:203], a[104:107], v[240:243], v[200:203]
    v_exp_f32 v230, v230
    v_mfma_f32_16x16x32_bf16 v[204:207], a[108:111], v[240:243], v[204:207]
    s_add_u32 m0, s44, 1600
    v_exp_f32 v231, v231
    v_mfma_f32_16x16x32_bf16 v[208:211], a[112:115], v[240:243], v[208:211]
    buffer_load_dwordx4 v8, s[16:19], s30 offen offset:512 lds
    v_cvt_pk_bf16_f32 v227, v230, v231
    v_mfma_f32_16x16x32_bf16 v[212:215], a[116:119], v[240:243], v[212:215]
    ds_read_b64_tr_b16 a[100:101], v4 offset:32
    ds_read_b64_tr_b16 a[102:103], v4 offset:288
    v_mfma_f32_16x16x32_bf16 v[216:219], a[120:123], v[240:243], v[216:219]
    ds_read_b64_tr_b16 a[104:105], v4 offset:64
    ds_read_b64_tr_b16 a[106:107], v4 offset:320
    v_mfma_f32_16x16x32_bf16 v[220:223], a[124:127], v[240:243], v[220:223]
    ds_read_b64_tr_b16 a[108:109], v4 offset:96
    ds_read_b64_tr_b16 a[110:111], v4 offset:352
    v_mfma_f32_16x16x32_bf16 v[240:243], a[64:67], v[80:83], 0
    v_exp_f32 v232, v232
    v_mfma_f32_16x16x32_bf16 v[240:243], a[68:71], v[84:87], v[240:243]
    s_add_u32 m0, s44, 2400
    v_exp_f32 v233, v233
    v_mfma_f32_16x16x32_bf16 v[240:243], a[72:75], v[88:91], v[240:243]
    buffer_load_dwordx4 v8, s[16:19], s30 offen offset:768 lds
    v_cvt_pk_bf16_f32 v232, v232, v233
    v_mfma_f32_16x16x32_bf16 v[240:243], a[76:79], v[92:95], v[240:243]
    v_exp_f32 v234, v234
    v_mfma_f32_16x16x32_bf16 v[244:247], a[92:95], v[92:95], 0
    v_exp_f32 v235, v235
    v_mfma_f32_16x16x32_bf16 v[244:247], a[88:91], v[88:91], v[244:247]
    ds_read_b64_tr_b16 a[112:113], v4 offset:128
    v_cvt_pk_bf16_f32 v233, v234, v235
    v_mfma_f32_16x16x32_bf16 v[244:247], a[84:87], v[84:87], v[244:247]
    ds_read_b64_tr_b16 a[114:115], v4 offset:384
    ds_read_b64_tr_b16 a[116:117], v4 offset:160
    v_mfma_f32_16x16x32_bf16 v[244:247], a[80:83], v[80:83], v[244:247]
    v_exp_f32 v236, v236
    v_mfma_f32_16x16x32_bf16 a[200:203], a[216:219], v[224:227], a[200:203]
    s_waitcnt lgkmcnt(15)
    s_add_u32 m0, s44, 67584
    v_exp_f32 v237, v237
    v_mfma_f32_16x16x32_bf16 v[128:131], a[128:131], v[224:227], v[128:131]
    buffer_load_dwordx4 v8, s[16:19], s31 offen offset:0 lds
    v_cvt_pk_bf16_f32 v234, v236, v237
    v_mfma_f32_16x16x32_bf16 v[132:135], a[132:135], v[224:227], v[132:135]
    ds_read_b64_tr_b16 a[118:119], v4 offset:416
    ds_read_b64_tr_b16 a[120:121], v4 offset:192
    v_mfma_f32_16x16x32_bf16 v[136:139], a[136:139], v[224:227], v[136:139]
    v_exp_f32 v238, v238
    v_mfma_f32_16x16x32_bf16 v[140:143], a[140:143], v[224:227], v[140:143]
    v_exp_f32 v239, v239
    v_mfma_f32_16x16x32_bf16 v[144:147], a[144:147], v[224:227], v[144:147]
    ds_read_b64_tr_b16 a[122:123], v4 offset:448
    v_cvt_pk_bf16_f32 v235, v238, v239
    v_mfma_f32_16x16x32_bf16 v[148:151], a[148:151], v[224:227], v[148:151]
    ds_read_b128 a[44:47], v0 offset:192
    ds_read_b128 a[48:51], v0 offset:256
    v_mfma_f32_16x16x32_bf16 v[152:155], a[152:155], v[224:227], v[152:155]
    ds_read_b128 a[52:55], v0 offset:320
    ds_read_b128 a[56:59], v0 offset:384
    v_mfma_f32_16x16x32_bf16 v[156:159], a[156:159], v[224:227], v[156:159]
    ds_read_b128 a[60:63], v0 offset:448
    s_waitcnt lgkmcnt(0)
    s_sub_u32 s35, 0, s35
    s_mov_b32 s32, 0
.p2align 6
L_loop:
    v_mfma_f32_16x16x32_bf16 a[204:207], a[216:219], v[232:235], a[204:207]
    v_exp_f32 v240, v240
    v_mfma_f32_16x16x32_bf16 v[160:163], a[128:131], v[232:235], v[160:163]
    v_exp_f32 v241, v241
    v_mfma_f32_16x16x32_bf16 v[164:167], a[132:135], v[232:235], v[164:167]
    ds_read_b64_tr_b16 a[124:125], v4 offset:224
    v_cvt_pk_bf16_f32 v240, v240, v241
    v_mfma_f32_16x16x32_bf16 v[168:171], a[136:139], v[232:235], v[168:171]
    v_exp_f32 v242, v242
    v_mfma_f32_16x16x32_bf16 v[172:175], a[140:143], v[232:235], v[172:175]
    v_exp_f32 v243, v243
    v_mfma_f32_16x16x32_bf16 v[176:179], a[144:147], v[232:235], v[176:179]
    ds_read_b64_tr_b16 a[126:127], v4 offset:480
    v_cvt_pk_bf16_f32 v241, v242, v243
    v_mfma_f32_16x16x32_bf16 v[180:183], a[148:151], v[232:235], v[180:183]
    v_mfma_f32_16x16x32_bf16 v[184:187], a[152:155], v[232:235], v[184:187]
    v_exp_f32 v244, v244
    v_mfma_f32_16x16x32_bf16 v[188:191], a[156:159], v[232:235], v[188:191]
    s_waitcnt lgkmcnt(15)
    v_exp_f32 v245, v245
    v_mfma_f32_16x16x32_bf16 v[224:227], a[32:35], v[16:19], 0
    s_add_u32 m0, s44, 68384
    v_add_u32 v0, s35, v0
    v_mfma_f32_16x16x32_bf16 v[224:227], a[36:39], v[20:23], v[224:227]
    buffer_load_dwordx4 v8, s[16:19], s31 offen offset:256 lds
    v_mfma_f32_16x16x32_bf16 v[224:227], a[40:43], v[24:27], v[224:227]
    v_exp_f32 v246, v246
    v_mfma_f32_16x16x32_bf16 v[224:227], a[44:47], v[28:31], v[224:227]
    v_exp_f32 v247, v247
    v_mfma_f32_16x16x32_bf16 v[228:231], a[60:63], v[28:31], 0
    ds_read_b128 a[64:67], v1 offset:0
    v_cvt_pk_bf16_f32 v242, v244, v245
    v_mfma_f32_16x16x32_bf16 v[228:231], a[56:59], v[24:27], v[228:231]
    ds_read_b128 a[68:71], v1 offset:64
    v_cvt_pk_bf16_f32 v243, v246, v247
    v_mfma_f32_16x16x32_bf16 v[228:231], a[52:55], v[20:23], v[228:231]
    ds_read_b128 a[72:75], v1 offset:128
    v_mfma_f32_16x16x32_bf16 v[228:231], a[48:51], v[16:19], v[228:231]
    ds_read_b128 a[76:79], v1 offset:192
    v_mfma_f32_16x16x32_bf16 v[236:239], a[48:51], v[32:35], 0
    v_exp_f32 v224, v224
    v_mfma_f32_16x16x32_bf16 v[236:239], a[52:55], v[36:39], v[236:239]
    v_exp_f32 v225, v225
    v_mfma_f32_16x16x32_bf16 v[236:239], a[56:59], v[40:43], v[236:239]
    ds_read_b128 a[80:83], v1 offset:256
    v_cvt_pk_bf16_f32 v224, v224, v225
    v_mfma_f32_16x16x32_bf16 v[236:239], a[60:63], v[44:47], v[236:239]
    v_exp_f32 v226, v226
    v_mfma_f32_16x16x32_bf16 v[232:235], a[44:47], v[44:47], 0
    v_exp_f32 v227, v227
    v_mfma_f32_16x16x32_bf16 v[232:235], a[40:43], v[40:43], v[232:235]
    s_add_u32 m0, s44, 69184
    ds_read_b128 a[84:87], v1 offset:320
    v_cvt_pk_bf16_f32 v225, v226, v227
    v_mfma_f32_16x16x32_bf16 v[232:235], a[36:39], v[36:39], v[232:235]
    buffer_load_dwordx4 v8, s[16:19], s31 offen offset:512 lds
    v_mfma_f32_16x16x32_bf16 v[232:235], a[32:35], v[32:35], v[232:235]
    v_exp_f32 v228, v228
    v_mfma_f32_16x16x32_bf16 v[192:195], a[128:131], v[240:243], v[192:195]
    v_exp_f32 v229, v229
    v_mfma_f32_16x16x32_bf16 v[196:199], a[132:135], v[240:243], v[196:199]
    ds_read_b128 a[88:91], v1 offset:384
    v_cvt_pk_bf16_f32 v226, v228, v229
    v_mfma_f32_16x16x32_bf16 v[200:203], a[136:139], v[240:243], v[200:203]
    ds_read_b128 a[92:95], v1 offset:448
    v_mfma_f32_16x16x32_bf16 v[204:207], a[140:143], v[240:243], v[204:207]
    v_exp_f32 v230, v230
    v_mfma_f32_16x16x32_bf16 v[208:211], a[144:147], v[240:243], v[208:211]
    v_exp_f32 v231, v231
    v_mfma_f32_16x16x32_bf16 v[212:215], a[148:151], v[240:243], v[212:215]
    v_cvt_pk_bf16_f32 v227, v230, v231
    v_add_u32 v4, s35, v4
    v_mfma_f32_16x16x32_bf16 v[216:219], a[152:155], v[240:243], v[216:219]
    ds_read_b64_tr_b16 a[128:129], v5 offset:0
    v_mfma_f32_16x16x32_bf16 v[220:223], a[156:159], v[240:243], v[220:223]
    ds_read_b64_tr_b16 a[130:131], v5 offset:256
    v_mfma_f32_16x16x32_bf16 a[208:211], a[216:219], v[240:243], a[208:211]
    ds_read_b64_tr_b16 a[132:133], v5 offset:32
    v_mfma_f32_16x16x32_bf16 a[192:195], a[216:219], v[224:227], a[192:195]
    s_waitcnt lgkmcnt(11)
    v_exp_f32 v232, v232
    v_mfma_f32_16x16x32_bf16 a[0:3], a[96:99], v[224:227], a[0:3]
    v_exp_f32 v233, v233
    v_mfma_f32_16x16x32_bf16 a[4:7], a[100:103], v[224:227], a[4:7]
    ds_read_b64_tr_b16 a[134:135], v5 offset:288
    v_cvt_pk_bf16_f32 v232, v232, v233
    v_mfma_f32_16x16x32_bf16 a[8:11], a[104:107], v[224:227], a[8:11]
    v_exp_f32 v234, v234
    v_mfma_f32_16x16x32_bf16 a[12:15], a[108:111], v[224:227], a[12:15]
    v_exp_f32 v235, v235
    v_mfma_f32_16x16x32_bf16 a[16:19], a[112:115], v[224:227], a[16:19]
    s_add_u32 m0, s44, 69984
    ds_read_b64_tr_b16 a[136:137], v5 offset:64
    v_cvt_pk_bf16_f32 v233, v234, v235
    v_mfma_f32_16x16x32_bf16 a[20:23], a[116:119], v[224:227], a[20:23]
    buffer_load_dwordx4 v8, s[16:19], s31 offen offset:768 lds
    v_mfma_f32_16x16x32_bf16 a[24:27], a[120:123], v[224:227], a[24:27]
    v_exp_f32 v236, v236
    v_mfma_f32_16x16x32_bf16 a[28:31], a[124:127], v[224:227], a[28:31]
    v_exp_f32 v237, v237
    v_mfma_f32_16x16x32_bf16 v[240:243], a[32:35], v[48:51], 0
    ds_read_b64_tr_b16 a[138:139], v5 offset:320
    v_mfma_f32_16x16x32_bf16 v[240:243], a[36:39], v[52:55], v[240:243]
    ds_read_b64_tr_b16 a[140:141], v5 offset:96
    v_mfma_f32_16x16x32_bf16 v[240:243], a[40:43], v[56:59], v[240:243]
    v_exp_f32 v238, v238
    v_mfma_f32_16x16x32_bf16 v[240:243], a[44:47], v[60:63], v[240:243]
    v_exp_f32 v239, v239
    v_mfma_f32_16x16x32_bf16 v[244:247], a[60:63], v[60:63], 0
    ds_read_b64_tr_b16 a[142:143], v5 offset:352
    v_cvt_pk_bf16_f32 v234, v236, v237
    v_mfma_f32_16x16x32_bf16 v[244:247], a[56:59], v[56:59], v[244:247]
    s_add_u32 m0, s44, 16896
    ds_read_b64_tr_b16 a[144:145], v5 offset:128
    v_cvt_pk_bf16_f32 v235, v238, v239
    v_mfma_f32_16x16x32_bf16 v[244:247], a[52:55], v[52:55], v[244:247]
    buffer_load_dwordx4 v8, s[20:23], s30 offen offset:0 lds
    v_mfma_f32_16x16x32_bf16 v[244:247], a[48:51], v[48:51], v[244:247]
    ds_read_b64_tr_b16 a[146:147], v5 offset:384
    v_mfma_f32_16x16x32_bf16 v[228:231], a[48:51], v[64:67], 0
    v_exp_f32 v240, v240
    v_mfma_f32_16x16x32_bf16 v[228:231], a[52:55], v[68:71], v[228:231]
    v_exp_f32 v241, v241
    v_mfma_f32_16x16x32_bf16 v[228:231], a[56:59], v[72:75], v[228:231]
    ds_read_b64_tr_b16 a[148:149], v5 offset:160
    v_cvt_pk_bf16_f32 v240, v240, v241
    v_mfma_f32_16x16x32_bf16 v[228:231], a[60:63], v[76:79], v[228:231]
    v_exp_f32 v242, v242
    v_mfma_f32_16x16x32_bf16 v[224:227], a[44:47], v[76:79], 0
    v_exp_f32 v243, v243
    v_mfma_f32_16x16x32_bf16 v[224:227], a[40:43], v[72:75], v[224:227]
    ds_read_b64_tr_b16 a[150:151], v5 offset:416
    v_cvt_pk_bf16_f32 v241, v242, v243
    v_mfma_f32_16x16x32_bf16 v[224:227], a[36:39], v[68:71], v[224:227]
    ds_read_b64_tr_b16 a[152:153], v5 offset:192
    v_mfma_f32_16x16x32_bf16 v[224:227], a[32:35], v[64:67], v[224:227]
    v_exp_f32 v244, v244
    v_mfma_f32_16x16x32_bf16 v[96:99], a[96:99], v[232:235], v[96:99]
    v_exp_f32 v245, v245
    v_mfma_f32_16x16x32_bf16 v[100:103], a[100:103], v[232:235], v[100:103]
    s_add_u32 m0, s44, 17696
    ds_read_b64_tr_b16 a[154:155], v5 offset:448
    v_cvt_pk_bf16_f32 v242, v244, v245
    v_mfma_f32_16x16x32_bf16 v[104:107], a[104:107], v[232:235], v[104:107]
    buffer_load_dwordx4 v8, s[20:23], s30 offen offset:256 lds
    v_mfma_f32_16x16x32_bf16 v[108:111], a[108:111], v[232:235], v[108:111]
    v_exp_f32 v246, v246
    v_mfma_f32_16x16x32_bf16 v[112:115], a[112:115], v[232:235], v[112:115]
    v_exp_f32 v247, v247
    v_mfma_f32_16x16x32_bf16 v[116:119], a[116:119], v[232:235], v[116:119]
    ds_read_b64_tr_b16 a[156:157], v5 offset:224
    v_cvt_pk_bf16_f32 v243, v246, v247
    v_mfma_f32_16x16x32_bf16 v[120:123], a[120:123], v[232:235], v[120:123]
    ds_read_b64_tr_b16 a[158:159], v5 offset:480
    v_mfma_f32_16x16x32_bf16 v[124:127], a[124:127], v[232:235], v[124:127]
L_pad2:
    s_cbranch_vccnz L_padret
    v_add_u32 v1, s35, v1
    v_mfma_f32_16x16x32_bf16 a[196:199], a[216:219], v[232:235], a[196:199]
    v_add_u32 v5, s35, v5
    v_mfma_f32_16x16x32_bf16 a[200:203], a[216:219], v[240:243], a[200:203]
    v_exp_f32 v224, v224
    v_mfma_f32_16x16x32_bf16 v[128:131], a[96:99], v[240:243], v[128:131]
    v_exp_f32 v225, v225
    v_mfma_f32_16x16x32_bf16 v[132:135], a[100:103], v[240:243], v[132:135]
    v_cvt_pk_bf16_f32 v224, v224, v225
    v_mfma_f32_16x16x32_bf16 v[136:139], a[104:107], v[240:243], v[136:139]
    v_exp_f32 v226, v226
    v_mfma_f32_16x16x32_bf16 v[140:143], a[108:111], v[240:243], v[140:143]
    v_exp_f32 v227, v227
    v_mfma_f32_16x16x32_bf16 v[144:147], a[112:115], v[240:243], v[144:147]
    s_add_u32 m0, s44, 18496
    v_cvt_pk_bf16_f32 v225, v226, v227
    v_mfma_f32_16x16x32_bf16 v[148:151], a[116:119], v[240:243], v[148:151]
    buffer_load_dwordx4 v8, s[20:23], s30 offen offset:512 lds
    v_mfma_f32_16x16x32_bf16 v[152:155], a[120:123], v[240:243], v[152:155]
    v_exp_f32 v228, v228
    v_mfma_f32_16x16x32_bf16 v[156:159], a[124:127], v[240:243], v[156:159]
    v_exp_f32 v229, v229
    v_mfma_f32_16x16x32_bf16 v[232:235], a[32:35], v[80:83], 0
    v_mfma_f32_16x16x32_bf16 v[232:235], a[36:39], v[84:87], v[232:235]
    v_mfma_f32_16x16x32_bf16 v[232:235], a[40:43], v[88:91], v[232:235]
    v_exp_f32 v230, v230
    v_mfma_f32_16x16x32_bf16 v[232:235], a[44:47], v[92:95], v[232:235]
    v_exp_f32 v231, v231
    v_mfma_f32_16x16x32_bf16 v[236:239], a[60:63], v[92:95], 0
    v_cvt_pk_bf16_f32 v226, v228, v229
    v_mfma_f32_16x16x32_bf16 v[236:239], a[56:59], v[88:91], v[236:239]
    s_add_u32 m0, s44, 19296
    v_cvt_pk_bf16_f32 v227, v230, v231
    v_mfma_f32_16x16x32_bf16 v[236:239], a[52:55], v[84:87], v[236:239]
    buffer_load_dwordx4 v8, s[20:23], s30 offen offset:768 lds
    v_mfma_f32_16x16x32_bf16 v[236:239], a[48:51], v[80:83], v[236:239]
    v_mfma_f32_16x16x32_bf16 v[244:247], a[48:51], a[220:223], 0
    v_exp_f32 v232, v232
    v_mfma_f32_16x16x32_bf16 v[244:247], a[52:55], a[224:227], v[244:247]
    v_exp_f32 v233, v233
    v_mfma_f32_16x16x32_bf16 v[244:247], a[56:59], a[228:231], v[244:247]
    v_cvt_pk_bf16_f32 v232, v232, v233
    v_mfma_f32_16x16x32_bf16 v[244:247], a[60:63], a[232:235], v[244:247]
    v_exp_f32 v234, v234
    v_mfma_f32_16x16x32_bf16 v[240:243], a[44:47], a[232:235], 0
    v_exp_f32 v235, v235
    v_mfma_f32_16x16x32_bf16 v[240:243], a[40:43], a[228:231], v[240:243]
    v_cvt_pk_bf16_f32 v233, v234, v235
    v_mfma_f32_16x16x32_bf16 v[240:243], a[36:39], a[224:227], v[240:243]
    v_mfma_f32_16x16x32_bf16 v[240:243], a[32:35], a[220:223], v[240:243]
    v_exp_f32 v236, v236
    v_mfma_f32_16x16x32_bf16 v[160:163], a[96:99], v[224:227], v[160:163]
    v_exp_f32 v237, v237
    v_mfma_f32_16x16x32_bf16 v[164:167], a[100:103], v[224:227], v[164:167]
    s_add_u32 m0, s44, 84480
    ds_read_b128 a[32:35], v2 offset:0
    v_cvt_pk_bf16_f32 v234, v236, v237
    v_mfma_f32_16x16x32_bf16 v[168:171], a[104:107], v[224:227], v[168:171]
    buffer_load_dwordx4 v8, s[20:23], s31 offen offset:0 lds
    v_mfma_f32_16x16x32_bf16 v[172:175], a[108:111], v[224:227], v[172:175]
    v_exp_f32 v238, v238
    v_mfma_f32_16x16x32_bf16 v[176:179], a[112:115], v[224:227], v[176:179]
    v_exp_f32 v239, v239
    v_mfma_f32_16x16x32_bf16 v[180:183], a[116:119], v[224:227], v[180:183]
    ds_read_b128 a[36:39], v2 offset:64
    v_cvt_pk_bf16_f32 v235, v238, v239
    v_mfma_f32_16x16x32_bf16 v[184:187], a[120:123], v[224:227], v[184:187]
    ds_read_b128 a[40:43], v2 offset:128
    v_mfma_f32_16x16x32_bf16 v[188:191], a[124:127], v[224:227], v[188:191]
    ds_read_b128 a[44:47], v2 offset:192
    v_mfma_f32_16x16x32_bf16 a[204:207], a[216:219], v[224:227], a[204:207]
    ds_read_b128 a[48:51], v2 offset:256
    v_mfma_f32_16x16x32_bf16 a[208:211], a[216:219], v[232:235], a[208:211]
    v_exp_f32 v240, v240
    v_mfma_f32_16x16x32_bf16 v[192:195], a[96:99], v[232:235], v[192:195]
    v_exp_f32 v241, v241
    v_mfma_f32_16x16x32_bf16 v[196:199], a[100:103], v[232:235], v[196:199]
    ds_read_b128 a[52:55], v2 offset:320
    v_cvt_pk_bf16_f32 v240, v240, v241
    v_mfma_f32_16x16x32_bf16 v[200:203], a[104:107], v[232:235], v[200:203]
    v_exp_f32 v242, v242
    v_mfma_f32_16x16x32_bf16 v[204:207], a[108:111], v[232:235], v[204:207]
    v_exp_f32 v243, v243
    v_mfma_f32_16x16x32_bf16 v[208:211], a[112:115], v[232:235], v[208:211]
    s_add_u32 m0, s44, 85280
    ds_read_b128 a[56:59], v2 offset:384
    v_cvt_pk_bf16_f32 v241, v242, v243
    v_mfma_f32_16x16x32_bf16 v[212:215], a[116:119], v[232:235], v[212:215]
    buffer_load_dwordx4 v8, s[20:23], s31 offen offset:256 lds
    v_mfma_f32_16x16x32_bf16 v[216:219], a[120:123], v[232:235], v[216:219]
    v_exp_f32 v244, v244
    v_mfma_f32_16x16x32_bf16 v[220:223], a[124:127], v[232:235], v[220:223]
    s_waitcnt lgkmcnt(15)
    v_exp_f32 v245, v245
    v_mfma_f32_16x16x32_bf16 v[224:227], a[64:67], v[16:19], 0
    ds_read_b128 a[60:63], v2 offset:448
    v_mfma_f32_16x16x32_bf16 v[224:227], a[68:71], v[20:23], v[224:227]
    v_add_u32 v2, s35, v2
    v_mfma_f32_16x16x32_bf16 v[224:227], a[72:75], v[24:27], v[224:227]
    v_exp_f32 v246, v246
    v_mfma_f32_16x16x32_bf16 v[224:227], a[76:79], v[28:31], v[224:227]
    v_exp_f32 v247, v247
    v_mfma_f32_16x16x32_bf16 v[228:231], a[92:95], v[28:31], 0
    v_cvt_pk_bf16_f32 v242, v244, v245
    v_mfma_f32_16x16x32_bf16 v[228:231], a[88:91], v[24:27], v[228:231]
    v_cvt_pk_bf16_f32 v243, v246, v247
    v_mfma_f32_16x16x32_bf16 v[228:231], a[84:87], v[20:23], v[228:231]
    s_add_u32 m0, s44, 86080
    v_mfma_f32_16x16x32_bf16 v[228:231], a[80:83], v[16:19], v[228:231]
    buffer_load_dwordx4 v8, s[20:23], s31 offen offset:512 lds
    v_mfma_f32_16x16x32_bf16 v[236:239], a[80:83], v[32:35], 0
    v_exp_f32 v224, v224
    v_mfma_f32_16x16x32_bf16 v[236:239], a[84:87], v[36:39], v[236:239]
    v_exp_f32 v225, v225
    v_mfma_f32_16x16x32_bf16 v[236:239], a[88:91], v[40:43], v[236:239]
    v_cvt_pk_bf16_f32 v224, v224, v225
    v_mfma_f32_16x16x32_bf16 v[236:239], a[92:95], v[44:47], v[236:239]
    v_exp_f32 v226, v226
    v_mfma_f32_16x16x32_bf16 v[232:235], a[76:79], v[44:47], 0
    v_exp_f32 v227, v227
    v_mfma_f32_16x16x32_bf16 v[232:235], a[72:75], v[40:43], v[232:235]
    v_cvt_pk_bf16_f32 v225, v226, v227
    v_mfma_f32_16x16x32_bf16 v[232:235], a[68:71], v[36:39], v[232:235]
    v_mfma_f32_16x16x32_bf16 v[232:235], a[64:67], v[32:35], v[232:235]
    v_exp_f32 v228, v228
    v_mfma_f32_16x16x32_bf16 a[160:163], a[96:99], v[240:243], a[160:163]
    v_exp_f32 v229, v229
    v_mfma_f32_16x16x32_bf16 a[164:167], a[100:103], v[240:243], a[164:167]
    ds_read_b64_tr_b16 a[96:97], v6 offset:0
    v_cvt_pk_bf16_f32 v226, v228, v229
    v_mfma_f32_16x16x32_bf16 a[168:171], a[104:107], v[240:243], a[168:171]
    ds_read_b64_tr_b16 a[98:99], v6 offset:256
    v_mfma_f32_16x16x32_bf16 a[172:175], a[108:111], v[240:243], a[172:175]
    v_exp_f32 v230, v230
    v_mfma_f32_16x16x32_bf16 a[176:179], a[112:115], v[240:243], a[176:179]
    v_exp_f32 v231, v231
    v_mfma_f32_16x16x32_bf16 a[180:183], a[116:119], v[240:243], a[180:183]
    s_add_u32 m0, s44, 86880
    ds_read_b64_tr_b16 a[100:101], v6 offset:32
    v_cvt_pk_bf16_f32 v227, v230, v231
    v_mfma_f32_16x16x32_bf16 a[184:187], a[120:123], v[240:243], a[184:187]
    buffer_load_dwordx4 v8, s[20:23], s31 offen offset:768 lds
    v_mfma_f32_16x16x32_bf16 a[188:191], a[124:127], v[240:243], a[188:191]
    ds_read_b64_tr_b16 a[102:103], v6 offset:288
    v_mfma_f32_16x16x32_bf16 a[212:215], a[216:219], v[240:243], a[212:215]
    ds_read_b64_tr_b16 a[104:105], v6 offset:64
    v_mfma_f32_16x16x32_bf16 a[192:195], a[216:219], v[224:227], a[192:195]
    s_waitcnt lgkmcnt(13)
    v_exp_f32 v232, v232
    v_mfma_f32_16x16x32_bf16 a[0:3], a[128:131], v[224:227], a[0:3]
    v_exp_f32 v233, v233
    v_mfma_f32_16x16x32_bf16 a[4:7], a[132:135], v[224:227], a[4:7]
    ds_read_b64_tr_b16 a[106:107], v6 offset:320
    v_cvt_pk_bf16_f32 v232, v232, v233
    v_mfma_f32_16x16x32_bf16 a[8:11], a[136:139], v[224:227], a[8:11]
    v_exp_f32 v234, v234
    v_mfma_f32_16x16x32_bf16 a[12:15], a[140:143], v[224:227], a[12:15]
    v_exp_f32 v235, v235
    v_mfma_f32_16x16x32_bf16 a[16:19], a[144:147], v[224:227], a[16:19]
    ds_read_b64_tr_b16 a[108:109], v6 offset:96
    v_cvt_pk_bf16_f32 v233, v234, v235
    v_mfma_f32_16x16x32_bf16 a[20:23], a[148:151], v[224:227], a[20:23]
    ds_read_b64_tr_b16 a[110:111], v6 offset:352
    v_mfma_f32_16x16x32_bf16 a[24:27], a[152:155], v[224:227], a[24:27]
    v_exp_f32 v236, v236
    v_mfma_f32_16x16x32_bf16 a[28:31], a[156:159], v[224:227], a[28:31]
    v_exp_f32 v237, v237
    v_mfma_f32_16x16x32_bf16 v[240:243], a[64:67], v[48:51], 0
    ds_read_b64_tr_b16 a[112:113], v6 offset:128
    v_mfma_f32_16x16x32_bf16 v[240:243], a[68:71], v[52:55], v[240:243]
    ds_read_b64_tr_b16 a[114:115], v6 offset:384
    v_mfma_f32_16x16x32_bf16 v[240:243], a[72:75], v[56:59], v[240:243]
    v_exp_f32 v238, v238
    v_mfma_f32_16x16x32_bf16 v[240:243], a[76:79], v[60:63], v[240:243]
    v_exp_f32 v239, v239
    v_mfma_f32_16x16x32_bf16 v[244:247], a[92:95], v[60:63], 0
    ds_read_b64_tr_b16 a[116:117], v6 offset:160
    v_cvt_pk_bf16_f32 v234, v236, v237
    v_mfma_f32_16x16x32_bf16 v[244:247], a[88:91], v[56:59], v[244:247]
    ds_read_b64_tr_b16 a[118:119], v6 offset:416
    v_cvt_pk_bf16_f32 v235, v238, v239
    v_mfma_f32_16x16x32_bf16 v[244:247], a[84:87], v[52:55], v[244:247]
    ds_read_b64_tr_b16 a[120:121], v6 offset:192
    v_mfma_f32_16x16x32_bf16 v[244:247], a[80:83], v[48:51], v[244:247]
    ds_read_b64_tr_b16 a[122:123], v6 offset:448
    v_mfma_f32_16x16x32_bf16 v[228:231], a[80:83], v[64:67], 0
    v_exp_f32 v240, v240
    v_mfma_f32_16x16x32_bf16 v[228:231], a[84:87], v[68:71], v[228:231]
    v_exp_f32 v241, v241
    v_mfma_f32_16x16x32_bf16 v[228:231], a[88:91], v[72:75], v[228:231]
    ds_read_b64_tr_b16 a[124:125], v6 offset:224
    v_cvt_pk_bf16_f32 v240, v240, v241
    v_mfma_f32_16x16x32_bf16 v[228:231], a[92:95], v[76:79], v[228:231]
    v_exp_f32 v242, v242
    v_mfma_f32_16x16x32_bf16 v[224:227], a[76:79], v[76:79], 0
    v_exp_f32 v243, v243
    v_mfma_f32_16x16x32_bf16 v[224:227], a[72:75], v[72:75], v[224:227]
    ds_read_b64_tr_b16 a[126:127], v6 offset:480
    v_cvt_pk_bf16_f32 v241, v242, v243
    v_mfma_f32_16x16x32_bf16 v[224:227], a[68:71], v[68:71], v[224:227]
    v_add_u32 v6, s35, v6
    v_mfma_f32_16x16x32_bf16 v[224:227], a[64:67], v[64:67], v[224:227]
    v_exp_f32 v244, v244
    v_mfma_f32_16x16x32_bf16 v[96:99], a[128:131], v[232:235], v[96:99]
    v_exp_f32 v245, v245
    v_mfma_f32_16x16x32_bf16 v[100:103], a[132:135], v[232:235], v[100:103]
    v_cvt_pk_bf16_f32 v242, v244, v245
    v_mfma_f32_16x16x32_bf16 v[104:107], a[136:139], v[232:235], v[104:107]
    v_mfma_f32_16x16x32_bf16 v[108:111], a[140:143], v[232:235], v[108:111]
    v_exp_f32 v246, v246
    v_mfma_f32_16x16x32_bf16 v[112:115], a[144:147], v[232:235], v[112:115]
    v_exp_f32 v247, v247
    v_mfma_f32_16x16x32_bf16 v[116:119], a[148:151], v[232:235], v[116:119]
    v_cvt_pk_bf16_f32 v243, v246, v247
    v_mfma_f32_16x16x32_bf16 v[120:123], a[152:155], v[232:235], v[120:123]
    v_mfma_f32_16x16x32_bf16 v[124:127], a[156:159], v[232:235], v[124:127]
    v_mfma_f32_16x16x32_bf16 a[196:199], a[216:219], v[232:235], a[196:199]
    v_mfma_f32_16x16x32_bf16 a[200:203], a[216:219], v[240:243], a[200:203]
    v_exp_f32 v224, v224
    v_mfma_f32_16x16x32_bf16 v[128:131], a[128:131], v[240:243], v[128:131]
    v_exp_f32 v225, v225
    v_mfma_f32_16x16x32_bf16 v[132:135], a[132:135], v[240:243], v[132:135]
    v_cvt_pk_bf16_f32 v224, v224, v225
    v_mfma_f32_16x16x32_bf16 v[136:139], a[136:139], v[240:243], v[136:139]
    v_exp_f32 v226, v226
    v_mfma_f32_16x16x32_bf16 v[140:143], a[140:143], v[240:243], v[140:143]
    v_exp_f32 v227, v227
    v_mfma_f32_16x16x32_bf16 v[144:147], a[144:147], v[240:243], v[144:147]
    v_cvt_pk_bf16_f32 v225, v226, v227
    v_mfma_f32_16x16x32_bf16 v[148:151], a[148:151], v[240:243], v[148:151]
    v_mfma_f32_16x16x32_bf16 v[152:155], a[152:155], v[240:243], v[152:155]
    v_exp_f32 v228, v228
    v_mfma_f32_16x16x32_bf16 v[156:159], a[156:159], v[240:243], v[156:159]
    v_exp_f32 v229, v229
    v_mfma_f32_16x16x32_bf16 v[232:235], a[64:67], v[80:83], 0
    ds_read_b128 a[64:67], v3 offset:0
    v_mfma_f32_16x16x32_bf16 v[232:235], a[68:71], v[84:87], v[232:235]
    ds_read_b128 a[68:71], v3 offset:64
    v_mfma_f32_16x16x32_bf16 v[232:235], a[72:75], v[88:91], v[232:235]
    v_exp_f32 v230, v230
    v_mfma_f32_16x16x32_bf16 v[232:235], a[76:79], v[92:95], v[232:235]
    v_exp_f32 v231, v231
    v_mfma_f32_16x16x32_bf16 v[236:239], a[92:95], v[92:95], 0
    ds_read_b128 a[72:75], v3 offset:128
    v_cvt_pk_bf16_f32 v226, v228, v229
    v_mfma_f32_16x16x32_bf16 v[236:239], a[88:91], v[88:91], v[236:239]
    ds_read_b128 a[76:79], v3 offset:192
    v_cvt_pk_bf16_f32 v227, v230, v231
    v_mfma_f32_16x16x32_bf16 v[236:239], a[84:87], v[84:87], v[236:239]
    v_mfma_f32_16x16x32_bf16 v[236:239], a[80:83], v[80:83], v[236:239]
    s_waitcnt lgkmcnt(15)
    ds_read_b128 a[80:83], v3 offset:256
    v_mfma_f32_16x16x32_bf16 v[244:247], a[48:51], v[16:19], 0
    v_exp_f32 v232, v232
    v_mfma_f32_16x16x32_bf16 v[244:247], a[52:55], v[20:23], v[244:247]
    v_exp_f32 v233, v233
    v_mfma_f32_16x16x32_bf16 v[244:247], a[56:59], v[24:27], v[244:247]
    ds_read_b128 a[84:87], v3 offset:320
    v_cvt_pk_bf16_f32 v232, v232, v233
    v_mfma_f32_16x16x32_bf16 v[244:247], a[60:63], v[28:31], v[244:247]
    s_waitcnt lgkmcnt(15)
    v_exp_f32 v234, v234
    v_mfma_f32_16x16x32_bf16 v[240:243], a[44:47], v[28:31], 0
    s_waitcnt lgkmcnt(15)
    v_exp_f32 v235, v235
    v_mfma_f32_16x16x32_bf16 v[240:243], a[40:43], v[24:27], v[240:243]
    s_waitcnt lgkmcnt(15)
    ds_read_b128 a[88:91], v3 offset:384
    v_cvt_pk_bf16_f32 v233, v234, v235
    v_mfma_f32_16x16x32_bf16 v[240:243], a[36:39], v[20:23], v[240:243]
    s_waitcnt lgkmcnt(15)
    ds_read_b128 a[92:95], v3 offset:448
    v_mfma_f32_16x16x32_bf16 v[240:243], a[32:35], v[16:19], v[240:243]
    v_exp_f32 v236, v236
    v_mfma_f32_16x16x32_bf16 v[160:163], a[128:131], v[224:227], v[160:163]
    v_exp_f32 v237, v237
    v_mfma_f32_16x16x32_bf16 v[164:167], a[132:135], v[224:227], v[164:167]
    v_cvt_pk_bf16_f32 v234, v236, v237
    v_add_u32 v3, s35, v3
    v_mfma_f32_16x16x32_bf16 v[168:171], a[136:139], v[224:227], v[168:171]
    v_mfma_f32_16x16x32_bf16 v[172:175], a[140:143], v[224:227], v[172:175]
    v_exp_f32 v238, v238
    v_mfma_f32_16x16x32_bf16 v[176:179], a[144:147], v[224:227], v[176:179]
    v_exp_f32 v239, v239
    v_mfma_f32_16x16x32_bf16 v[180:183], a[148:151], v[224:227], v[180:183]
    v_cvt_pk_bf16_f32 v235, v238, v239
    v_mfma_f32_16x16x32_bf16 v[184:187], a[152:155], v[224:227], v[184:187]
    v_mfma_f32_16x16x32_bf16 v[188:191], a[156:159], v[224:227], v[188:191]
    v_mfma_f32_16x16x32_bf16 a[204:207], a[216:219], v[224:227], a[204:207]
    v_mfma_f32_16x16x32_bf16 a[208:211], a[216:219], v[232:235], a[208:211]
    v_exp_f32 v240, v240
    v_mfma_f32_16x16x32_bf16 v[192:195], a[128:131], v[232:235], v[192:195]
    v_exp_f32 v241, v241
    v_mfma_f32_16x16x32_bf16 v[196:199], a[132:135], v[232:235], v[196:199]
    ds_read_b64_tr_b16 a[128:129], v7 offset:0
    v_cvt_pk_bf16_f32 v240, v240, v241
    v_mfma_f32_16x16x32_bf16 v[200:203], a[136:139], v[232:235], v[200:203]
    v_exp_f32 v242, v242
    v_mfma_f32_16x16x32_bf16 v[204:207], a[140:143], v[232:235], v[204:207]
    v_exp_f32 v243, v243
    v_mfma_f32_16x16x32_bf16 v[208:211], a[144:147], v[232:235], v[208:211]
    ds_read_b64_tr_b16 a[130:131], v7 offset:256
    v_cvt_pk_bf16_f32 v241, v242, v243
    v_mfma_f32_16x16x32_bf16 v[212:215], a[148:151], v[232:235], v[212:215]
    ds_read_b64_tr_b16 a[132:133], v7 offset:32
    v_mfma_f32_16x16x32_bf16 v[216:219], a[152:155], v[232:235], v[216:219]
    v_exp_f32 v244, v244
    v_mfma_f32_16x16x32_bf16 v[220:223], a[156:159], v[232:235], v[220:223]
    v_exp_f32 v245, v245
    v_mfma_f32_16x16x32_bf16 v[224:227], a[32:35], v[32:35], 0
    ds_read_b64_tr_b16 a[134:135], v7 offset:288
    v_mfma_f32_16x16x32_bf16 v[224:227], a[36:39], v[36:39], v[224:227]
    ds_read_b64_tr_b16 a[136:137], v7 offset:64
    v_mfma_f32_16x16x32_bf16 v[224:227], a[40:43], v[40:43], v[224:227]
    v_exp_f32 v246, v246
    v_mfma_f32_16x16x32_bf16 v[224:227], a[44:47], v[44:47], v[224:227]
    v_exp_f32 v247, v247
    v_mfma_f32_16x16x32_bf16 v[228:231], a[60:63], v[44:47], 0
    ds_read_b64_tr_b16 a[138:139], v7 offset:320
    v_cvt_pk_bf16_f32 v242, v244, v245
    v_mfma_f32_16x16x32_bf16 v[228:231], a[56:59], v[40:43], v[228:231]
    ds_read_b64_tr_b16 a[140:141], v7 offset:96
    v_cvt_pk_bf16_f32 v243, v246, v247
    v_mfma_f32_16x16x32_bf16 v[228:231], a[52:55], v[36:39], v[228:231]
    ds_read_b64_tr_b16 a[142:143], v7 offset:352
    v_mfma_f32_16x16x32_bf16 v[228:231], a[48:51], v[32:35], v[228:231]
    ds_read_b64_tr_b16 a[144:145], v7 offset:128
    v_mfma_f32_16x16x32_bf16 v[236:239], a[48:51], v[48:51], 0
    v_exp_f32 v224, v224
    v_mfma_f32_16x16x32_bf16 v[236:239], a[52:55], v[52:55], v[236:239]
    v_exp_f32 v225, v225
    v_mfma_f32_16x16x32_bf16 v[236:239], a[56:59], v[56:59], v[236:239]
    ds_read_b64_tr_b16 a[146:147], v7 offset:384
    v_cvt_pk_bf16_f32 v224, v224, v225
    v_mfma_f32_16x16x32_bf16 v[236:239], a[60:63], v[60:63], v[236:239]
    v_exp_f32 v226, v226
    v_mfma_f32_16x16x32_bf16 v[232:235], a[44:47], v[60:63], 0
    v_exp_f32 v227, v227
    v_mfma_f32_16x16x32_bf16 v[232:235], a[40:43], v[56:59], v[232:235]
    ds_read_b64_tr_b16 a[148:149], v7 offset:160
    v_cvt_pk_bf16_f32 v225, v226, v227
    v_mfma_f32_16x16x32_bf16 v[232:235], a[36:39], v[52:55], v[232:235]
    ds_read_b64_tr_b16 a[150:151], v7 offset:416
    v_mfma_f32_16x16x32_bf16 v[232:235], a[32:35], v[48:51], v[232:235]
    s_waitcnt lgkmcnt(15)
    v_exp_f32 v228, v228
    v_mfma_f32_16x16x32_bf16 a[0:3], a[96:99], v[240:243], a[0:3]
    v_exp_f32 v229, v229
    v_mfma_f32_16x16x32_bf16 a[4:7], a[100:103], v[240:243], a[4:7]
    ds_read_b64_tr_b16 a[152:153], v7 offset:192
    v_cvt_pk_bf16_f32 v226, v228, v229
    v_mfma_f32_16x16x32_bf16 a[8:11], a[104:107], v[240:243], a[8:11]
    ds_read_b64_tr_b16 a[154:155], v7 offset:448
    v_mfma_f32_16x16x32_bf16 a[12:15], a[108:111], v[240:243], a[12:15]
    v_exp_f32 v230, v230
    v_mfma_f32_16x16x32_bf16 a[16:19], a[112:115], v[240:243], a[16:19]
    v_exp_f32 v231, v231
    v_mfma_f32_16x16x32_bf16 a[20:23], a[116:119], v[240:243], a[20:23]
    ds_read_b64_tr_b16 a[156:157], v7 offset:224
    v_cvt_pk_bf16_f32 v227, v230, v231
    v_mfma_f32_16x16x32_bf16 a[24:27], a[120:123], v[240:243], a[24:27]
    ds_read_b64_tr_b16 a[158:159], v7 offset:480
    v_mfma_f32_16x16x32_bf16 a[28:31], a[124:127], v[240:243], a[28:31]
    v_add_u32 v7, s35, v7
    v_mfma_f32_16x16x32_bf16 a[192:195], a[216:219], v[240:243], a[192:195]
    v_mfma_f32_16x16x32_bf16 a[196:199], a[216:219], v[224:227], a[196:199]
    v_exp_f32 v232, v232
    v_mfma_f32_16x16x32_bf16 v[96:99], a[96:99], v[224:227], v[96:99]
    v_exp_f32 v233, v233
    v_mfma_f32_16x16x32_bf16 v[100:103], a[100:103], v[224:227], v[100:103]
    v_cvt_pk_bf16_f32 v232, v232, v233
    v_mfma_f32_16x16x32_bf16 v[104:107], a[104:107], v[224:227], v[104:107]
    v_exp_f32 v234, v234
    v_mfma_f32_16x16x32_bf16 v[108:111], a[108:111], v[224:227], v[108:111]
    v_exp_f32 v235, v235
    v_mfma_f32_16x16x32_bf16 v[112:115], a[112:115], v[224:227], v[112:115]
    v_cvt_pk_bf16_f32 v233, v234, v235
    v_mfma_f32_16x16x32_bf16 v[116:119], a[116:119], v[224:227], v[116:119]
    v_mfma_f32_16x16x32_bf16 v[120:123], a[120:123], v[224:227], v[120:123]
    v_exp_f32 v236, v236
    v_mfma_f32_16x16x32_bf16 v[124:127], a[124:127], v[224:227], v[124:127]
    v_exp_f32 v237, v237
    v_mfma_f32_16x16x32_bf16 v[240:243], a[32:35], v[64:67], 0
    v_mfma_f32_16x16x32_bf16 v[240:243], a[36:39], v[68:71], v[240:243]
    v_mfma_f32_16x16x32_bf16 v[240:243], a[40:43], v[72:75], v[240:243]
    v_exp_f32 v238, v238
    v_mfma_f32_16x16x32_bf16 v[240:243], a[44:47], v[76:79], v[240:243]
    v_exp_f32 v239, v239
    v_mfma_f32_16x16x32_bf16 v[244:247], a[60:63], v[76:79], 0
    v_cvt_pk_bf16_f32 v234, v236, v237
    v_mfma_f32_16x16x32_bf16 v[244:247], a[56:59], v[72:75], v[244:247]
    v_cvt_pk_bf16_f32 v235, v238, v239
    v_mfma_f32_16x16x32_bf16 v[244:247], a[52:55], v[68:71], v[244:247]
    v_mfma_f32_16x16x32_bf16 v[244:247], a[48:51], v[64:67], v[244:247]
    v_mfma_f32_16x16x32_bf16 v[228:231], a[48:51], v[80:83], 0
    v_exp_f32 v240, v240
    v_mfma_f32_16x16x32_bf16 v[228:231], a[52:55], v[84:87], v[228:231]
    v_exp_f32 v241, v241
    v_mfma_f32_16x16x32_bf16 v[228:231], a[56:59], v[88:91], v[228:231]
    v_cvt_pk_bf16_f32 v240, v240, v241
    v_mfma_f32_16x16x32_bf16 v[228:231], a[60:63], v[92:95], v[228:231]
    v_exp_f32 v242, v242
    v_mfma_f32_16x16x32_bf16 v[224:227], a[44:47], v[92:95], 0
    v_exp_f32 v243, v243
    v_mfma_f32_16x16x32_bf16 v[224:227], a[40:43], v[88:91], v[224:227]
    v_cvt_pk_bf16_f32 v241, v242, v243
    v_mfma_f32_16x16x32_bf16 v[224:227], a[36:39], v[84:87], v[224:227]
    v_mfma_f32_16x16x32_bf16 v[224:227], a[32:35], v[80:83], v[224:227]
    v_exp_f32 v244, v244
    v_mfma_f32_16x16x32_bf16 v[128:131], a[96:99], v[232:235], v[128:131]
    v_exp_f32 v245, v245
    v_mfma_f32_16x16x32_bf16 v[132:135], a[100:103], v[232:235], v[132:135]
    v_cvt_pk_bf16_f32 v242, v244, v245
    v_mfma_f32_16x16x32_bf16 v[136:139], a[104:107], v[232:235], v[136:139]
    v_mfma_f32_16x16x32_bf16 v[140:143], a[108:111], v[232:235], v[140:143]
    v_exp_f32 v246, v246
    v_mfma_f32_16x16x32_bf16 v[144:147], a[112:115], v[232:235], v[144:147]
    v_exp_f32 v247, v247
    v_mfma_f32_16x16x32_bf16 v[148:151], a[116:119], v[232:235], v[148:151]
    v_cvt_pk_bf16_f32 v243, v246, v247
    v_mfma_f32_16x16x32_bf16 v[152:155], a[120:123], v[232:235], v[152:155]
    v_mfma_f32_16x16x32_bf16 v[156:159], a[124:127], v[232:235], v[156:159]
    v_mfma_f32_16x16x32_bf16 a[200:203], a[216:219], v[232:235], a[200:203]
    v_mfma_f32_16x16x32_bf16 a[204:207], a[216:219], v[240:243], a[204:207]
    v_exp_f32 v224, v224
    v_mfma_f32_16x16x32_bf16 v[160:163], a[96:99], v[240:243], v[160:163]
    v_exp_f32 v225, v225
    v_mfma_f32_16x16x32_bf16 v[164:167], a[100:103], v[240:243], v[164:167]
    v_cvt_pk_bf16_f32 v224, v224, v225
    v_mfma_f32_16x16x32_bf16 v[168:171], a[104:107], v[240:243], v[168:171]
    v_exp_f32 v226, v226
    v_mfma_f32_16x16x32_bf16 v[172:175], a[108:111], v[240:243], v[172:175]
    v_exp_f32 v227, v227
    v_mfma_f32_16x16x32_bf16 v[176:179], a[112:115], v[240:243], v[176:179]
    v_cvt_pk_bf16_f32 v225, v226, v227
    v_mfma_f32_16x16x32_bf16 v[180:183], a[116:119], v[240:243], v[180:183]
    v_mfma_f32_16x16x32_bf16 v[184:187], a[120:123], v[240:243], v[184:187]
    v_exp_f32 v228, v228
    v_mfma_f32_16x16x32_bf16 v[188:191], a[124:127], v[240:243], v[188:191]
    s_waitcnt lgkmcnt(15)
    v_exp_f32 v229, v229
    v_mfma_f32_16x16x32_bf16 v[232:235], a[64:67], v[16:19], 0
    v_mfma_f32_16x16x32_bf16 v[232:235], a[68:71], v[20:23], v[232:235]
    v_mfma_f32_16x16x32_bf16 v[232:235], a[72:75], v[24:27], v[232:235]
    v_exp_f32 v230, v230
    v_mfma_f32_16x16x32_bf16 v[232:235], a[76:79], v[28:31], v[232:235]
    v_exp_f32 v231, v231
    v_mfma_f32_16x16x32_bf16 v[236:239], a[92:95], v[28:31], 0
    v_cvt_pk_bf16_f32 v226, v228, v229
    v_mfma_f32_16x16x32_bf16 v[236:239], a[88:91], v[24:27], v[236:239]
    v_cvt_pk_bf16_f32 v227, v230, v231
    v_mfma_f32_16x16x32_bf16 v[236:239], a[84:87], v[20:23], v[236:239]
    v_mfma_f32_16x16x32_bf16 v[236:239], a[80:83], v[16:19], v[236:239]
    v_mfma_f32_16x16x32_bf16 v[244:247], a[80:83], v[32:35], 0
    v_exp_f32 v232, v232
    v_mfma_f32_16x16x32_bf16 v[244:247], a[84:87], v[36:39], v[244:247]
    v_exp_f32 v233, v233
    v_mfma_f32_16x16x32_bf16 v[244:247], a[88:91], v[40:43], v[244:247]
    v_cvt_pk_bf16_f32 v232, v232, v233
    v_mfma_f32_16x16x32_bf16 v[244:247], a[92:95], v[44:47], v[244:247]
    v_exp_f32 v234, v234
    v_mfma_f32_16x16x32_bf16 v[240:243], a[76:79], v[44:47], 0
    v_exp_f32 v235, v235
    v_mfma_f32_16x16x32_bf16 v[240:243], a[72:75], v[40:43], v[240:243]
    v_cvt_pk_bf16_f32 v233, v234, v235
    v_mfma_f32_16x16x32_bf16 v[240:243], a[68:71], v[36:39], v[240:243]
    v_mfma_f32_16x16x32_bf16 v[240:243], a[64:67], v[32:35], v[240:243]
    s_add_u32 s30, s30, 32768
    v_exp_f32 v236, v236
    v_mfma_f32_16x16x32_bf16 v[192:195], a[96:99], v[224:227], v[192:195]
    s_and_b32 s30, s30, 262143
    v_exp_f32 v237, v237
    v_mfma_f32_16x16x32_bf16 v[196:199], a[100:103], v[224:227], v[196:199]
    s_add_u32 s31, s30, 16384
    v_cvt_pk_bf16_f32 v234, v236, v237
    v_mfma_f32_16x16x32_bf16 v[200:203], a[104:107], v[224:227], v[200:203]
    s_add_u32 s44, s44, s58
    v_mfma_f32_16x16x32_bf16 v[204:207], a[108:111], v[224:227], v[204:207]
    s_sub_u32 s58, 0, s58
    v_exp_f32 v238, v238
    v_mfma_f32_16x16x32_bf16 v[208:211], a[112:115], v[224:227], v[208:211]
    s_cmp_lt_u32 s32, 5
    v_exp_f32 v239, v239
    v_mfma_f32_16x16x32_bf16 v[212:215], a[116:119], v[224:227], v[212:215]
    s_cselect_b32 s18, 262144, 0
    v_cvt_pk_bf16_f32 v235, v238, v239
    v_mfma_f32_16x16x32_bf16 v[216:219], a[120:123], v[224:227], v[216:219]
    s_cselect_b32 s22, 262144, 0
    v_mfma_f32_16x16x32_bf16 v[220:223], a[124:127], v[224:227], v[220:223]
    s_cselect_b32 s44, s44, 0x30000
    v_mfma_f32_16x16x32_bf16 a[208:211], a[216:219], v[224:227], a[208:211]
    s_waitcnt vmcnt(0)
    s_waitcnt lgkmcnt(0)
    s_barrier
    v_mfma_f32_16x16x32_bf16 a[192:195], a[216:219], v[232:235], a[192:195]
    s_waitcnt lgkmcnt(15)
    v_exp_f32 v240, v240
    v_mfma_f32_16x16x32_bf16 a[0:3], a[128:131], v[232:235], a[0:3]
    v_exp_f32 v241, v241
    v_mfma_f32_16x16x32_bf16 a[4:7], a[132:135], v[232:235], a[4:7]
    ds_read_b128 a[32:35], v0 offset:0
    v_cvt_pk_bf16_f32 v240, v240, v241
    v_mfma_f32_16x16x32_bf16 a[8:11], a[136:139], v[232:235], a[8:11]
    v_exp_f32 v242, v242
    v_mfma_f32_16x16x32_bf16 a[12:15], a[140:143], v[232:235], a[12:15]
    v_exp_f32 v243, v243
    v_mfma_f32_16x16x32_bf16 a[16:19], a[144:147], v[232:235], a[16:19]
    s_add_u32 m0, s44, 0
    ds_read_b128 a[36:39], v0 offset:64
    v_cvt_pk_bf16_f32 v241, v242, v243
    v_mfma_f32_16x16x32_bf16 a[20:23], a[148:151], v[232:235], a[20:23]
    buffer_load_dwordx4 v8, s[16:19], s30 offen offset:0 lds
    v_mfma_f32_16x16x32_bf16 a[24:27], a[152:155], v[232:235], a[24:27]
    v_exp_f32 v244, v244
    v_mfma_f32_16x16x32_bf16 a[28:31], a[156:159], v[232:235], a[28:31]
    v_exp_f32 v245, v245
    v_mfma_f32_16x16x32_bf16 v[224:227], a[64:67], v[48:51], 0
    ds_read_b128 a[40:43], v0 offset:128
    v_mfma_f32_16x16x32_bf16 v[224:227], a[68:71], v[52:55], v[224:227]
    ds_read_b128 a[44:47], v0 offset:192
    v_mfma_f32_16x16x32_bf16 v[224:227], a[72:75], v[56:59], v[224:227]
    v_exp_f32 v246, v246
    v_mfma_f32_16x16x32_bf16 v[224:227], a[76:79], v[60:63], v[224:227]
    v_exp_f32 v247, v247
    v_mfma_f32_16x16x32_bf16 v[228:231], a[92:95], v[60:63], 0
    ds_read_b128 a[48:51], v0 offset:256
    v_cvt_pk_bf16_f32 v242, v244, v245
    v_mfma_f32_16x16x32_bf16 v[228:231], a[88:91], v[56:59], v[228:231]
    s_add_u32 m0, s44, 800
    ds_read_b128 a[52:55], v0 offset:320
    v_cvt_pk_bf16_f32 v243, v246, v247
    v_mfma_f32_16x16x32_bf16 v[228:231], a[84:87], v[52:55], v[228:231]
    buffer_load_dwordx4 v8, s[16:19], s30 offen offset:256 lds
    v_mfma_f32_16x16x32_bf16 v[228:231], a[80:83], v[48:51], v[228:231]
    ds_read_b128 a[56:59], v0 offset:384
    v_mfma_f32_16x16x32_bf16 v[236:239], a[80:83], v[64:67], 0
    v_exp_f32 v224, v224
    v_mfma_f32_16x16x32_bf16 v[236:239], a[84:87], v[68:71], v[236:239]
    v_exp_f32 v225, v225
    v_mfma_f32_16x16x32_bf16 v[236:239], a[88:91], v[72:75], v[236:239]
    ds_read_b128 a[60:63], v0 offset:448
    v_cvt_pk_bf16_f32 v224, v224, v225
    v_mfma_f32_16x16x32_bf16 v[236:239], a[92:95], v[76:79], v[236:239]
    v_exp_f32 v226, v226
    v_mfma_f32_16x16x32_bf16 v[232:235], a[76:79], v[76:79], 0
    v_exp_f32 v227, v227
    v_mfma_f32_16x16x32_bf16 v[232:235], a[72:75], v[72:75], v[232:235]
    ds_read_b64_tr_b16 a[96:97], v4 offset:0
    v_cvt_pk_bf16_f32 v225, v226, v227
    v_mfma_f32_16x16x32_bf16 v[232:235], a[68:71], v[68:71], v[232:235]
    ds_read_b64_tr_b16 a[98:99], v4 offset:256
    v_mfma_f32_16x16x32_bf16 v[232:235], a[64:67], v[64:67], v[232:235]
    v_exp_f32 v228, v228
    v_mfma_f32_16x16x32_bf16 a[196:199], a[216:219], v[240:243], a[196:199]
    v_exp_f32 v229, v229
    v_mfma_f32_16x16x32_bf16 v[96:99], a[128:131], v[240:243], v[96:99]
    s_add_u32 m0, s44, 1600
    ds_read_b64_tr_b16 a[100:101], v4 offset:32
    v_cvt_pk_bf16_f32 v226, v228, v229
    v_mfma_f32_16x16x32_bf16 v[100:103], a[132:135], v[240:243], v[100:103]
    buffer_load_dwordx4 v8, s[16:19], s30 offen offset:512 lds
    v_mfma_f32_16x16x32_bf16 v[104:107], a[136:139], v[240:243], v[104:107]
    v_exp_f32 v230, v230
    v_mfma_f32_16x16x32_bf16 v[108:111], a[140:143], v[240:243], v[108:111]
    v_exp_f32 v231, v231
    v_mfma_f32_16x16x32_bf16 v[112:115], a[144:147], v[240:243], v[112:115]
    ds_read_b64_tr_b16 a[102:103], v4 offset:288
    v_cvt_pk_bf16_f32 v227, v230, v231
    v_mfma_f32_16x16x32_bf16 v[116:119], a[148:151], v[240:243], v[116:119]
    ds_read_b64_tr_b16 a[104:105], v4 offset:64
    v_mfma_f32_16x16x32_bf16 v[120:123], a[152:155], v[240:243], v[120:123]
    ds_read_b64_tr_b16 a[106:107], v4 offset:320
    v_mfma_f32_16x16x32_bf16 v[124:127], a[156:159], v[240:243], v[124:127]
    ds_read_b64_tr_b16 a[108:109], v4 offset:96
    v_mfma_f32_16x16x32_bf16 v[240:243], a[64:67], v[80:83], 0
    v_exp_f32 v232, v232
    v_mfma_f32_16x16x32_bf16 v[240:243], a[68:71], v[84:87], v[240:243]
    v_exp_f32 v233, v233
    v_mfma_f32_16x16x32_bf16 v[240:243], a[72:75], v[88:91], v[240:243]
    ds_read_b64_tr_b16 a[110:111], v4 offset:352
    v_cvt_pk_bf16_f32 v232, v232, v233
    v_mfma_f32_16x16x32_bf16 v[240:243], a[76:79], v[92:95], v[240:243]
    v_exp_f32 v234, v234
    v_mfma_f32_16x16x32_bf16 v[244:247], a[92:95], v[92:95], 0
    v_exp_f32 v235, v235
    v_mfma_f32_16x16x32_bf16 v[244:247], a[88:91], v[88:91], v[244:247]
    s_add_u32 m0, s44, 2400
    ds_read_b64_tr_b16 a[112:113], v4 offset:128
    v_cvt_pk_bf16_f32 v233, v234, v235
    v_mfma_f32_16x16x32_bf16 v[244:247], a[84:87], v[84:87], v[244:247]
L_pad3:
    s_cbranch_vccnz L_padret
    buffer_load_dwordx4 v8, s[16:19], s30 offen offset:768 lds
    v_mfma_f32_16x16x32_bf16 v[244:247], a[80:83], v[80:83], v[244:247]
    v_exp_f32 v236, v236
    v_mfma_f32_16x16x32_bf16 v[128:131], a[128:131], v[224:227], v[128:131]
    v_exp_f32 v237, v237
    v_mfma_f32_16x16x32_bf16 v[132:135], a[132:135], v[224:227], v[132:135]
    ds_read_b64_tr_b16 a[114:115], v4 offset:384
    v_cvt_pk_bf16_f32 v234, v236, v237
    v_mfma_f32_16x16x32_bf16 v[136:139], a[136:139], v[224:227], v[136:139]
    ds_read_b64_tr_b16 a[116:117], v4 offset:160
    v_mfma_f32_16x16x32_bf16 v[140:143], a[140:143], v[224:227], v[140:143]
    v_exp_f32 v238, v238
    v_mfma_f32_16x16x32_bf16 v[144:147], a[144:147], v[224:227], v[144:147]
    v_exp_f32 v239, v239
    v_mfma_f32_16x16x32_bf16 v[148:151], a[148:151], v[224:227], v[148:151]
    s_add_u32 s32, s32, 1
    ds_read_b64_tr_b16 a[118:119], v4 offset:416
    v_cvt_pk_bf16_f32 v235, v238, v239
    v_mfma_f32_16x16x32_bf16 v[152:155], a[152:155], v[224:227], v[152:155]
    s_add_u32 m0, s44, 67584
    ds_read_b64_tr_b16 a[120:121], v4 offset:192
    v_mfma_f32_16x16x32_bf16 v[156:159], a[156:159], v[224:227], v[156:159]
    s_sub_u32 s35, 0, s35
    buffer_load_dwordx4 v8, s[16:19], s31 offen offset:0 lds
    v_mfma_f32_16x16x32_bf16 a[200:203], a[216:219], v[224:227], a[200:203]
    s_cmp_lt_u32 s32, 6
    ds_read_b64_tr_b16 a[122:123], v4 offset:448
    s_cbranch_scc1 L_loop
    s_waitcnt lgkmcnt(14)
    v_mfma_f32_16x16x32_bf16 v[224:227], a[32:35], v[16:19], 0
    v_exp_f32 v240, v240
    v_mfma_f32_16x16x32_bf16 v[224:227], a[36:39], v[20:23], v[224:227]
    v_exp_f32 v241, v241
    v_mfma_f32_16x16x32_bf16 v[224:227], a[40:43], v[24:27], v[224:227]
    ds_read_b128 a[64:67], v1 offset:0
    v_cvt_pk_bf16_f32 v240, v240, v241
    v_mfma_f32_16x16x32_bf16 v[224:227], a[44:47], v[28:31], v[224:227]
    v_exp_f32 v242, v242
    v_mfma_f32_16x16x32_bf16 v[228:231], a[60:63], v[28:31], 0
    v_exp_f32 v243, v243
    v_mfma_f32_16x16x32_bf16 v[228:231], a[56:59], v[24:27], v[228:231]
    ds_read_b128 a[68:71], v1 offset:64
    v_cvt_pk_bf16_f32 v241, v242, v243
    v_mfma_f32_16x16x32_bf16 v[228:231], a[52:55], v[20:23], v[228:231]
    ds_read_b128 a[72:75], v1 offset:128
    ds_read_b128 a[76:79], v1 offset:192
    v_mfma_f32_16x16x32_bf16 v[228:231], a[48:51], v[16:19], v[228:231]
    v_exp_f32 v244, v244
    v_mfma_f32_16x16x32_bf16 a[204:207], a[216:219], v[232:235], a[204:207]
    s_waitcnt lgkmcnt(15)
    v_exp_f32 v245, v245
    v_mfma_f32_16x16x32_bf16 v[160:163], a[128:131], v[232:235], v[160:163]
    ds_read_b128 a[80:83], v1 offset:256
    v_cvt_pk_bf16_f32 v242, v244, v245
    v_mfma_f32_16x16x32_bf16 v[164:167], a[132:135], v[232:235], v[164:167]
    ds_read_b128 a[84:87], v1 offset:320
    ds_read_b128 a[88:91], v1 offset:384
    v_mfma_f32_16x16x32_bf16 v[168:171], a[136:139], v[232:235], v[168:171]
    v_exp_f32 v246, v246
    v_mfma_f32_16x16x32_bf16 v[172:175], a[140:143], v[232:235], v[172:175]
    v_exp_f32 v247, v247
    v_mfma_f32_16x16x32_bf16 v[176:179], a[144:147], v[232:235], v[176:179]
    ds_read_b128 a[92:95], v1 offset:448
    v_cvt_pk_bf16_f32 v243, v246, v247
    v_mfma_f32_16x16x32_bf16 v[180:183], a[148:151], v[232:235], v[180:183]
    ds_read_b64_tr_b16 a[124:125], v4 offset:224
    ds_read_b64_tr_b16 a[126:127], v4 offset:480
    v_mfma_f32_16x16x32_bf16 v[184:187], a[152:155], v[232:235], v[184:187]
    v_mfma_f32_16x16x32_bf16 v[188:191], a[156:159], v[232:235], v[188:191]
    v_mfma_f32_16x16x32_bf16 v[232:235], a[32:35], v[32:35], 0
    v_exp_f32 v224, v224
    v_mfma_f32_16x16x32_bf16 v[232:235], a[36:39], v[36:39], v[232:235]
    v_exp_f32 v225, v225
    v_mfma_f32_16x16x32_bf16 v[232:235], a[40:43], v[40:43], v[232:235]
    ds_read_b128 a[32:35], v2 offset:0
    v_cvt_pk_bf16_f32 v224, v224, v225
    v_mfma_f32_16x16x32_bf16 v[232:235], a[44:47], v[44:47], v[232:235]
    v_exp_f32 v226, v226
    v_mfma_f32_16x16x32_bf16 v[236:239], a[60:63], v[44:47], 0
    v_exp_f32 v227, v227
    v_mfma_f32_16x16x32_bf16 v[236:239], a[56:59], v[40:43], v[236:239]
    ds_read_b128 a[36:39], v2 offset:64
    v_cvt_pk_bf16_f32 v225, v226, v227
    v_mfma_f32_16x16x32_bf16 v[236:239], a[52:55], v[36:39], v[236:239]
    ds_read_b128 a[40:43], v2 offset:128
    ds_read_b128 a[44:47], v2 offset:192
    v_mfma_f32_16x16x32_bf16 v[236:239], a[48:51], v[32:35], v[236:239]
    v_exp_f32 v228, v228
    v_mfma_f32_16x16x32_bf16 a[208:211], a[216:219], v[240:243], a[208:211]
    v_exp_f32 v229, v229
    v_mfma_f32_16x16x32_bf16 v[192:195], a[128:131], v[240:243], v[192:195]
    ds_read_b128 a[48:51], v2 offset:256
    v_cvt_pk_bf16_f32 v226, v228, v229
    v_mfma_f32_16x16x32_bf16 v[196:199], a[132:135], v[240:243], v[196:199]
    ds_read_b128 a[52:55], v2 offset:320
    ds_read_b128 a[56:59], v2 offset:384
    v_mfma_f32_16x16x32_bf16 v[200:203], a[136:139], v[240:243], v[200:203]
    v_exp_f32 v230, v230
    v_mfma_f32_16x16x32_bf16 v[204:207], a[140:143], v[240:243], v[204:207]
    v_exp_f32 v231, v231
    v_mfma_f32_16x16x32_bf16 v[208:211], a[144:147], v[240:243], v[208:211]
    ds_read_b128 a[60:63], v2 offset:448
    v_cvt_pk_bf16_f32 v227, v230, v231
    v_mfma_f32_16x16x32_bf16 v[212:215], a[148:151], v[240:243], v[212:215]
    ds_read_b64_tr_b16 a[128:129], v5 offset:0
    ds_read_b64_tr_b16 a[130:131], v5 offset:256
    v_mfma_f32_16x16x32_bf16 v[216:219], a[152:155], v[240:243], v[216:219]
    ds_read_b64_tr_b16 a[132:133], v5 offset:32
    ds_read_b64_tr_b16 a[134:135], v5 offset:288
    v_mfma_f32_16x16x32_bf16 v[220:223], a[156:159], v[240:243], v[220:223]
    s_waitcnt lgkmcnt(14)
    ds_read_b64_tr_b16 a[136:137], v5 offset:64
    ds_read_b64_tr_b16 a[138:139], v5 offset:320
    v_mfma_f32_16x16x32_bf16 v[240:243], a[64:67], v[16:19], 0
    v_exp_f32 v232, v232
    v_mfma_f32_16x16x32_bf16 v[240:243], a[68:71], v[20:23], v[240:243]
    v_exp_f32 v233, v233
    v_mfma_f32_16x16x32_bf16 v[240:243], a[72:75], v[24:27], v[240:243]
    ds_read_b64_tr_b16 a[140:141], v5 offset:96
    v_cvt_pk_bf16_f32 v232, v232, v233
    v_mfma_f32_16x16x32_bf16 v[240:243], a[76:79], v[28:31], v[240:243]
    v_exp_f32 v234, v234
    v_mfma_f32_16x16x32_bf16 v[244:247], a[92:95], v[28:31], 0
    v_exp_f32 v235, v235
    v_mfma_f32_16x16x32_bf16 v[244:247], a[88:91], v[24:27], v[244:247]
    ds_read_b64_tr_b16 a[142:143], v5 offset:352
    v_cvt_pk_bf16_f32 v233, v234, v235
    v_mfma_f32_16x16x32_bf16 v[244:247], a[84:87], v[20:23], v[244:247]
    ds_read_b64_tr_b16 a[144:145], v5 offset:128
    v_mfma_f32_16x16x32_bf16 v[244:247], a[80:83], v[16:19], v[244:247]
    v_exp_f32 v236, v236
    v_mfma_f32_16x16x32_bf16 a[192:195], a[216:219], v[224:227], a[192:195]
    s_waitcnt lgkmcnt(15)
    v_exp_f32 v237, v237
    v_mfma_f32_16x16x32_bf16 a[0:3], a[96:99], v[224:227], a[0:3]
    ds_read_b64_tr_b16 a[146:147], v5 offset:384
    v_cvt_pk_bf16_f32 v234, v236, v237
    v_mfma_f32_16x16x32_bf16 a[4:7], a[100:103], v[224:227], a[4:7]
    ds_read_b64_tr_b16 a[148:149], v5 offset:160
    v_mfma_f32_16x16x32_bf16 a[8:11], a[104:107], v[224:227], a[8:11]
    v_exp_f32 v238, v238
    v_mfma_f32_16x16x32_bf16 a[12:15], a[108:111], v[224:227], a[12:15]
    v_exp_f32 v239, v239
    v_mfma_f32_16x16x32_bf16 a[16:19], a[112:115], v[224:227], a[16:19]
    ds_read_b64_tr_b16 a[150:151], v5 offset:416
    v_cvt_pk_bf16_f32 v235, v238, v239
    v_mfma_f32_16x16x32_bf16 a[20:23], a[116:119], v[224:227], a[20:23]
    ds_read_b64_tr_b16 a[152:153], v5 offset:192
    v_mfma_f32_16x16x32_bf16 a[24:27], a[120:123], v[224:227], a[24:27]
    ds_read_b64_tr_b16 a[154:155], v5 offset:448
    v_mfma_f32_16x16x32_bf16 a[28:31], a[124:127], v[224:227], a[28:31]
    ds_read_b64_tr_b16 a[156:157], v5 offset:224
    v_mfma_f32_16x16x32_bf16 v[224:227], a[64:67], v[32:35], 0
    v_exp_f32 v240, v240
    v_mfma_f32_16x16x32_bf16 v[224:227], a[68:71], v[36:39], v[224:227]
    v_exp_f32 v241, v241
    v_mfma_f32_16x16x32_bf16 v[224:227], a[72:75], v[40:43], v[224:227]
    ds_read_b64_tr_b16 a[158:159], v5 offset:480
    v_cvt_pk_bf16_f32 v240, v240, v241
    v_mfma_f32_16x16x32_bf16 v[224:227], a[76:79], v[44:47], v[224:227]
    v_exp_f32 v242, v242
    v_mfma_f32_16x16x32_bf16 v[228:231], a[92:95], v[44:47], 0
    v_exp_f32 v243, v243
    v_mfma_f32_16x16x32_bf16 v[228:231], a[88:91], v[40:43], v[228:231]
    ds_read_b128 a[64:67], v3 offset:0
    v_cvt_pk_bf16_f32 v241, v242, v243
    v_mfma_f32_16x16x32_bf16 v[228:231], a[84:87], v[36:39], v[228:231]
    ds_read_b128 a[68:71], v3 offset:64
    v_mfma_f32_16x16x32_bf16 v[228:231], a[80:83], v[32:35], v[228:231]
    v_exp_f32 v244, v244
    v_mfma_f32_16x16x32_bf16 a[196:199], a[216:219], v[232:235], a[196:199]
    v_exp_f32 v245, v245
    v_mfma_f32_16x16x32_bf16 v[96:99], a[96:99], v[232:235], v[96:99]
    ds_read_b128 a[72:75], v3 offset:128
    v_cvt_pk_bf16_f32 v242, v244, v245
    v_mfma_f32_16x16x32_bf16 v[100:103], a[100:103], v[232:235], v[100:103]
    ds_read_b128 a[76:79], v3 offset:192
    v_mfma_f32_16x16x32_bf16 v[104:107], a[104:107], v[232:235], v[104:107]
    v_exp_f32 v246, v246
    v_mfma_f32_16x16x32_bf16 v[108:111], a[108:111], v[232:235], v[108:111]
    v_exp_f32 v247, v247
    v_mfma_f32_16x16x32_bf16 v[112:115], a[112:115], v[232:235], v[112:115]
    ds_read_b128 a[80:83], v3 offset:256
    v_cvt_pk_bf16_f32 v243, v246, v247
    v_mfma_f32_16x16x32_bf16 v[116:119], a[116:119], v[232:235], v[116:119]
    ds_read_b128 a[84:87], v3 offset:320
    v_mfma_f32_16x16x32_bf16 v[120:123], a[120:123], v[232:235], v[120:123]
    ds_read_b128 a[88:91], v3 offset:384
    v_mfma_f32_16x16x32_bf16 v[124:127], a[124:127], v[232:235], v[124:127]
    s_waitcnt lgkmcnt(15)
    ds_read_b128 a[92:95], v3 offset:448
    v_mfma_f32_16x16x32_bf16 v[232:235], a[32:35], v[16:19], 0
    v_exp_f32 v224, v224
    v_mfma_f32_16x16x32_bf16 v[232:235], a[36:39], v[20:23], v[232:235]
    v_exp_f32 v225, v225
    v_mfma_f32_16x16x32_bf16 v[232:235], a[40:43], v[24:27], v[232:235]
    ds_read_b64_tr_b16 a[96:97], v6 offset:0
    v_cvt_pk_bf16_f32 v224, v224, v225
    v_mfma_f32_16x16x32_bf16 v[232:235], a[44:47], v[28:31], v[232:235]
    v_exp_f32 v226, v226
    v_mfma_f32_16x16x32_bf16 v[236:239], a[60:63], v[28:31], 0
    v_exp_f32 v227, v227
    v_mfma_f32_16x16x32_bf16 v[236:239], a[56:59], v[24:27], v[236:239]
    ds_read_b64_tr_b16 a[98:99], v6 offset:256
    v_cvt_pk_bf16_f32 v225, v226, v227
    v_mfma_f32_16x16x32_bf16 v[236:239], a[52:55], v[20:23], v[236:239]
    ds_read_b64_tr_b16 a[100:101], v6 offset:32
    v_mfma_f32_16x16x32_bf16 v[236:239], a[48:51], v[16:19], v[236:239]
    v_exp_f32 v228, v228
    v_mfma_f32_16x16x32_bf16 a[192:195], a[216:219], v[240:243], a[192:195]
    s_waitcnt lgkmcnt(11)
    v_exp_f32 v229, v229
    v_mfma_f32_16x16x32_bf16 a[0:3], a[128:131], v[240:243], a[0:3]
    ds_read_b64_tr_b16 a[102:103], v6 offset:288
    v_cvt_pk_bf16_f32 v226, v228, v229
    v_mfma_f32_16x16x32_bf16 a[4:7], a[132:135], v[240:243], a[4:7]
    ds_read_b64_tr_b16 a[104:105], v6 offset:64
    v_mfma_f32_16x16x32_bf16 a[8:11], a[136:139], v[240:243], a[8:11]
    v_exp_f32 v230, v230
    v_mfma_f32_16x16x32_bf16 a[12:15], a[140:143], v[240:243], a[12:15]
    v_exp_f32 v231, v231
    v_mfma_f32_16x16x32_bf16 a[16:19], a[144:147], v[240:243], a[16:19]
    ds_read_b64_tr_b16 a[106:107], v6 offset:320
    v_cvt_pk_bf16_f32 v227, v230, v231
    v_mfma_f32_16x16x32_bf16 a[20:23], a[148:151], v[240:243], a[20:23]
    ds_read_b64_tr_b16 a[108:109], v6 offset:96
    v_mfma_f32_16x16x32_bf16 a[24:27], a[152:155], v[240:243], a[24:27]
    ds_read_b64_tr_b16 a[110:111], v6 offset:352
    v_mfma_f32_16x16x32_bf16 a[28:31], a[156:159], v[240:243], a[28:31]
    s_waitcnt lgkmcnt(8)
    ds_read_b64_tr_b16 a[112:113], v6 offset:128
    v_mfma_f32_16x16x32_bf16 v[240:243], a[64:67], v[16:19], 0
    v_exp_f32 v232, v232
    v_mfma_f32_16x16x32_bf16 v[240:243], a[68:71], v[20:23], v[240:243]
    v_exp_f32 v233, v233
    v_mfma_f32_16x16x32_bf16 v[240:243], a[72:75], v[24:27], v[240:243]
    ds_read_b64_tr_b16 a[114:115], v6 offset:384
    v_cvt_pk_bf16_f32 v232, v232, v233
    v_mfma_f32_16x16x32_bf16 v[240:243], a[76:79], v[28:31], v[240:243]
    v_exp_f32 v234, v234
    v_mfma_f32_16x16x32_bf16 v[244:247], a[92:95], v[28:31], 0
    v_exp_f32 v235, v235
    v_mfma_f32_16x16x32_bf16 v[244:247], a[88:91], v[24:27], v[244:247]
    ds_read_b64_tr_b16 a[116:117], v6 offset:160
    v_cvt_pk_bf16_f32 v233, v234, v235
    v_mfma_f32_16x16x32_bf16 v[244:247], a[84:87], v[20:23], v[244:247]
    ds_read_b64_tr_b16 a[118:119], v6 offset:416
    v_mfma_f32_16x16x32_bf16 v[244:247], a[80:83], v[16:19], v[244:247]
    v_exp_f32 v236, v236
    v_mfma_f32_16x16x32_bf16 a[196:199], a[216:219], v[224:227], a[196:199]
    v_exp_f32 v237, v237
    v_mfma_f32_16x16x32_bf16 v[96:99], a[128:131], v[224:227], v[96:99]
    ds_read_b64_tr_b16 a[120:121], v6 offset:192
    v_cvt_pk_bf16_f32 v234, v236, v237
    v_mfma_f32_16x16x32_bf16 v[100:103], a[132:135], v[224:227], v[100:103]
    ds_read_b64_tr_b16 a[122:123], v6 offset:448
    v_mfma_f32_16x16x32_bf16 v[104:107], a[136:139], v[224:227], v[104:107]
    v_exp_f32 v238, v238
    v_mfma_f32_16x16x32_bf16 v[108:111], a[140:143], v[224:227], v[108:111]
    v_exp_f32 v239, v239
    v_mfma_f32_16x16x32_bf16 v[112:115], a[144:147], v[224:227], v[112:115]
    ds_read_b64_tr_b16 a[124:125], v6 offset:224
    v_cvt_pk_bf16_f32 v235, v238, v239
    v_mfma_f32_16x16x32_bf16 v[116:119], a[148:151], v[224:227], v[116:119]
    ds_read_b64_tr_b16 a[126:127], v6 offset:480
    v_mfma_f32_16x16x32_bf16 v[120:123], a[152:155], v[224:227], v[120:123]
    ds_read_b64_tr_b16 a[128:129], v7 offset:0
    v_mfma_f32_16x16x32_bf16 v[124:127], a[156:159], v[224:227], v[124:127]
    ds_read_b64_tr_b16 a[130:131], v7 offset:256
    v_mfma_f32_16x16x32_bf16 v[224:227], a[32:35], v[48:51], 0
    v_exp_f32 v240, v240
    v_mfma_f32_16x16x32_bf16 v[224:227], a[36:39], v[52:55], v[224:227]
    v_exp_f32 v241, v241
    v_mfma_f32_16x16x32_bf16 v[224:227], a[40:43], v[56:59], v[224:227]
    ds_read_b64_tr_b16 a[132:133], v7 offset:32
    v_cvt_pk_bf16_f32 v240, v240, v241
    v_mfma_f32_16x16x32_bf16 v[224:227], a[44:47], v[60:63], v[224:227]
    v_exp_f32 v242, v242
    v_mfma_f32_16x16x32_bf16 v[228:231], a[60:63], v[60:63], 0
    v_exp_f32 v243, v243
    v_mfma_f32_16x16x32_bf16 v[228:231], a[56:59], v[56:59], v[228:231]
    ds_read_b64_tr_b16 a[134:135], v7 offset:288
    v_cvt_pk_bf16_f32 v241, v242, v243
    v_mfma_f32_16x16x32_bf16 v[228:231], a[52:55], v[52:55], v[228:231]
    ds_read_b64_tr_b16 a[136:137], v7 offset:64
    v_mfma_f32_16x16x32_bf16 v[228:231], a[48:51], v[48:51], v[228:231]
    v_exp_f32 v244, v244
    v_mfma_f32_16x16x32_bf16 a[192:195], a[216:219], v[232:235], a[192:195]
    s_waitcnt lgkmcnt(5)
    v_exp_f32 v245, v245
    v_mfma_f32_16x16x32_bf16 a[0:3], a[96:99], v[232:235], a[0:3]
    ds_read_b64_tr_b16 a[138:139], v7 offset:320
    v_cvt_pk_bf16_f32 v242, v244, v245
    v_mfma_f32_16x16x32_bf16 a[4:7], a[100:103], v[232:235], a[4:7]
    ds_read_b64_tr_b16 a[140:141], v7 offset:96
    v_mfma_f32_16x16x32_bf16 a[8:11], a[104:107], v[232:235], a[8:11]
    v_exp_f32 v246, v246
    v_mfma_f32_16x16x32_bf16 a[12:15], a[108:111], v[232:235], a[12:15]
    v_exp_f32 v247, v247
    v_mfma_f32_16x16x32_bf16 a[16:19], a[112:115], v[232:235], a[16:19]
    ds_read_b64_tr_b16 a[142:143], v7 offset:352
    v_cvt_pk_bf16_f32 v243, v246, v247
    v_mfma_f32_16x16x32_bf16 a[20:23], a[116:119], v[232:235], a[20:23]
    ds_read_b64_tr_b16 a[144:145], v7 offset:128
    v_mfma_f32_16x16x32_bf16 a[24:27], a[120:123], v[232:235], a[24:27]
    ds_read_b64_tr_b16 a[146:147], v7 offset:384
    v_mfma_f32_16x16x32_bf16 a[28:31], a[124:127], v[232:235], a[28:31]
    ds_read_b64_tr_b16 a[148:149], v7 offset:160
    v_mfma_f32_16x16x32_bf16 v[232:235], a[64:67], v[48:51], 0
    v_exp_f32 v224, v224
    v_mfma_f32_16x16x32_bf16 v[232:235], a[68:71], v[52:55], v[232:235]
    v_exp_f32 v225, v225
    v_mfma_f32_16x16x32_bf16 v[232:235], a[72:75], v[56:59], v[232:235]
    ds_read_b64_tr_b16 a[150:151], v7 offset:416
    v_cvt_pk_bf16_f32 v224, v224, v225
    v_mfma_f32_16x16x32_bf16 v[232:235], a[76:79], v[60:63], v[232:235]
    v_exp_f32 v226, v226
    v_mfma_f32_16x16x32_bf16 v[236:239], a[92:95], v[60:63], 0
    v_exp_f32 v227, v227
    v_mfma_f32_16x16x32_bf16 v[236:239], a[88:91], v[56:59], v[236:239]
    ds_read_b64_tr_b16 a[152:153], v7 offset:192
    v_cvt_pk_bf16_f32 v225, v226, v227
    v_mfma_f32_16x16x32_bf16 v[236:239], a[84:87], v[52:55], v[236:239]
    ds_read_b64_tr_b16 a[154:155], v7 offset:448
    v_mfma_f32_16x16x32_bf16 v[236:239], a[80:83], v[48:51], v[236:239]
    v_exp_f32 v228, v228
    v_mfma_f32_16x16x32_bf16 a[192:195], a[216:219], v[240:243], a[192:195]
    s_waitcnt lgkmcnt(2)
    v_exp_f32 v229, v229
    v_mfma_f32_16x16x32_bf16 a[0:3], a[128:131], v[240:243], a[0:3]
    ds_read_b64_tr_b16 a[156:157], v7 offset:224
    v_cvt_pk_bf16_f32 v226, v228, v229
    v_mfma_f32_16x16x32_bf16 a[4:7], a[132:135], v[240:243], a[4:7]
    ds_read_b64_tr_b16 a[158:159], v7 offset:480
    v_mfma_f32_16x16x32_bf16 a[8:11], a[136:139], v[240:243], a[8:11]
    v_exp_f32 v230, v230
    v_mfma_f32_16x16x32_bf16 a[12:15], a[140:143], v[240:243], a[12:15]
    v_exp_f32 v231, v231
    v_mfma_f32_16x16x32_bf16 a[16:19], a[144:147], v[240:243], a[16:19]
    v_cvt_pk_bf16_f32 v227, v230, v231
    v_mfma_f32_16x16x32_bf16 a[20:23], a[148:151], v[240:243], a[20:23]
    s_waitcnt lgkmcnt(2)
    v_mfma_f32_16x16x32_bf16 a[24:27], a[152:155], v[240:243], a[24:27]
    s_waitcnt lgkmcnt(0)
    v_mfma_f32_16x16x32_bf16 a[28:31], a[156:159], v[240:243], a[28:31]
    v_accvgpr_read_b32 v15, a192
    v_rcp_f32 v14, v15
    v_accvgpr_read_b32 v248, a0
    v_accvgpr_read_b32 v249, a1
    v_accvgpr_read_b32 v250, a2
    v_accvgpr_read_b32 v251, a3
    v_mul_f32 v252, 0x75800000, v15
    v_mul_f32 v253, 0x7c800000, v14
    s_add_u32 s4, s45, 0
    v_pk_mul_f32 v[248:249], v[248:249], v[14:15] op_sel_hi:[1,0]
    v_pk_mul_f32 v[250:251], v[250:251], v[14:15] op_sel_hi:[1,0]
    v_cvt_pk_bf16_f32 v16, v248, v249
    v_cvt_pk_bf16_f32 v17, v250, v251
    v_pk_fma_f32 v[252:253], v[248:249], v[250:251], v[252:253]
    v_accvgpr_read_b32 v248, a4
    v_accvgpr_read_b32 v249, a5
    v_accvgpr_read_b32 v250, a6
    v_accvgpr_read_b32 v251, a7
    v_pk_mul_f32 v[248:249], v[248:249], v[14:15] op_sel_hi:[1,0]
    v_pk_mul_f32 v[250:251], v[250:251], v[14:15] op_sel_hi:[1,0]
    v_cvt_pk_bf16_f32 v18, v248, v249
    v_cvt_pk_bf16_f32 v19, v250, v251
    v_pk_fma_f32 v[252:253], v[248:249], v[250:251], v[252:253]
    v_accvgpr_read_b32 v248, a8
    v_accvgpr_read_b32 v249, a9
    v_accvgpr_read_b32 v250, a10
    v_accvgpr_read_b32 v251, a11
    v_permlane16_swap_b32 v16, v18
    v_permlane16_swap_b32 v17, v19
    v_pk_mul_f32 v[248:249], v[248:249], v[14:15] op_sel_hi:[1,0]
    v_pk_mul_f32 v[250:251], v[250:251], v[14:15] op_sel_hi:[1,0]
    v_cvt_pk_bf16_f32 v20, v248, v249
    v_cvt_pk_bf16_f32 v21, v250, v251
    v_pk_fma_f32 v[252:253], v[248:249], v[250:251], v[252:253]
    v_accvgpr_read_b32 v248, a12
    v_accvgpr_read_b32 v249, a13
    v_accvgpr_read_b32 v250, a14
    v_accvgpr_read_b32 v251, a15
    v_pk_mul_f32 v[248:249], v[248:249], v[14:15] op_sel_hi:[1,0]
    v_pk_mul_f32 v[250:251], v[250:251], v[14:15] op_sel_hi:[1,0]
    v_cvt_pk_bf16_f32 v22, v248, v249
    v_cvt_pk_bf16_f32 v23, v250, v251
    v_pk_fma_f32 v[252:253], v[248:249], v[250:251], v[252:253]
    v_accvgpr_read_b32 v248, a16
    v_accvgpr_read_b32 v249, a17
    v_accvgpr_read_b32 v250, a18
    v_accvgpr_read_b32 v251, a19
    v_permlane16_swap_b32 v20, v22
    v_permlane16_swap_b32 v21, v23
    v_pk_mul_f32 v[248:249], v[248:249], v[14:15] op_sel_hi:[1,0]
    v_pk_mul_f32 v[250:251], v[250:251], v[14:15] op_sel_hi:[1,0]
    v_cvt_pk_bf16_f32 v24, v248, v249
    v_cvt_pk_bf16_f32 v25, v250, v251
    v_pk_fma_f32 v[252:253], v[248:249], v[250:251], v[252:253]
    v_accvgpr_read_b32 v248, a20
    v_accvgpr_read_b32 v249, a21
    v_accvgpr_read_b32 v250, a22
    v_accvgpr_read_b32 v251, a23
    v_pk_mul_f32 v[248:249], v[248:249], v[14:15] op_sel_hi:[1,0]
    v_pk_mul_f32 v[250:251], v[250:251], v[14:15] op_sel_hi:[1,0]
    v_cvt_pk_bf16_f32 v26, v248, v249
    v_cvt_pk_bf16_f32 v27, v250, v251
    v_pk_fma_f32 v[252:253], v[248:249], v[250:251], v[252:253]
    v_accvgpr_read_b32 v248, a24
    v_accvgpr_read_b32 v249, a25
    v_accvgpr_read_b32 v250, a26
    v_accvgpr_read_b32 v251, a27
    v_permlane16_swap_b32 v24, v26
    v_permlane16_swap_b32 v25, v27
    v_pk_mul_f32 v[248:249], v[248:249], v[14:15] op_sel_hi:[1,0]
    v_pk_mul_f32 v[250:251], v[250:251], v[14:15] op_sel_hi:[1,0]
    v_cvt_pk_bf16_f32 v28, v248, v249
    v_cvt_pk_bf16_f32 v29, v250, v251
    v_pk_fma_f32 v[252:253], v[248:249], v[250:251], v[252:253]
    v_accvgpr_read_b32 v248, a28
    v_accvgpr_read_b32 v249, a29
    v_accvgpr_read_b32 v250, a30
    v_accvgpr_read_b32 v251, a31
    v_pk_mul_f32 v[248:249], v[248:249], v[14:15] op_sel_hi:[1,0]
    v_pk_mul_f32 v[250:251], v[250:251], v[14:15] op_sel_hi:[1,0]
    v_cvt_pk_bf16_f32 v30, v248, v249
    v_cvt_pk_bf16_f32 v31, v250, v251
    v_pk_fma_f32 v[252:253], v[248:249], v[250:251], v[252:253]
    s_nop 0
    v_permlane16_swap_b32 v28, v30
    v_permlane16_swap_b32 v29, v31
    v_mfma_f32_16x16x32_bf16 v[240:243], a[32:35], v[32:35], 0
    v_exp_f32 v232, v232
    v_mfma_f32_16x16x32_bf16 v[240:243], a[36:39], v[36:39], v[240:243]
    v_exp_f32 v233, v233
    v_mfma_f32_16x16x32_bf16 v[240:243], a[40:43], v[40:43], v[240:243]
    buffer_store_dwordx4 v[16:19], v10, s[24:27], s4 offen offset:0 sc1
    v_cvt_pk_bf16_f32 v232, v232, v233
    v_mfma_f32_16x16x32_bf16 v[240:243], a[44:47], v[44:47], v[240:243]
    v_exp_f32 v234, v234
    v_mfma_f32_16x16x32_bf16 v[244:247], a[60:63], v[44:47], 0
    v_exp_f32 v235, v235
    v_mfma_f32_16x16x32_bf16 v[244:247], a[56:59], v[40:43], v[244:247]
    v_cvt_pk_bf16_f32 v233, v234, v235
    v_mfma_f32_16x16x32_bf16 v[244:247], a[52:55], v[36:39], v[244:247]
    v_mfma_f32_16x16x32_bf16 v[244:247], a[48:51], v[32:35], v[244:247]
    v_exp_f32 v236, v236
    v_mfma_f32_16x16x32_bf16 a[200:203], a[216:219], v[224:227], a[200:203]
    v_exp_f32 v237, v237
    v_mfma_f32_16x16x32_bf16 v[128:131], a[96:99], v[224:227], v[128:131]
    buffer_store_dwordx4 v[20:23], v10, s[24:27], s4 offen offset:64 sc1
    v_cvt_pk_bf16_f32 v234, v236, v237
    v_mfma_f32_16x16x32_bf16 v[132:135], a[100:103], v[224:227], v[132:135]
    v_mfma_f32_16x16x32_bf16 v[136:139], a[104:107], v[224:227], v[136:139]
    v_exp_f32 v238, v238
    v_mfma_f32_16x16x32_bf16 v[140:143], a[108:111], v[224:227], v[140:143]
    v_exp_f32 v239, v239
    v_mfma_f32_16x16x32_bf16 v[144:147], a[112:115], v[224:227], v[144:147]
    v_cvt_pk_bf16_f32 v235, v238, v239
    v_mfma_f32_16x16x32_bf16 v[148:151], a[116:119], v[224:227], v[148:151]
    v_mfma_f32_16x16x32_bf16 v[152:155], a[120:123], v[224:227], v[152:155]
    v_mfma_f32_16x16x32_bf16 v[156:159], a[124:127], v[224:227], v[156:159]
    buffer_store_dwordx4 v[24:27], v10, s[24:27], s4 offen offset:128 sc1
    v_mfma_f32_16x16x32_bf16 v[224:227], a[64:67], v[32:35], 0
    v_exp_f32 v240, v240
    v_mfma_f32_16x16x32_bf16 v[224:227], a[68:71], v[36:39], v[224:227]
    v_exp_f32 v241, v241
    v_mfma_f32_16x16x32_bf16 v[224:227], a[72:75], v[40:43], v[224:227]
    v_cvt_pk_bf16_f32 v240, v240, v241
    v_mfma_f32_16x16x32_bf16 v[224:227], a[76:79], v[44:47], v[224:227]
    v_exp_f32 v242, v242
    v_mfma_f32_16x16x32_bf16 v[228:231], a[92:95], v[44:47], 0
    v_exp_f32 v243, v243
    v_mfma_f32_16x16x32_bf16 v[228:231], a[88:91], v[40:43], v[228:231]
    v_cvt_pk_bf16_f32 v241, v242, v243
    v_mfma_f32_16x16x32_bf16 v[228:231], a[84:87], v[36:39], v[228:231]
    v_mfma_f32_16x16x32_bf16 v[228:231], a[80:83], v[32:35], v[228:231]
    v_exp_f32 v244, v244
    v_mfma_f32_16x16x32_bf16 a[200:203], a[216:219], v[232:235], a[200:203]
    v_exp_f32 v245, v245
    v_mfma_f32_16x16x32_bf16 v[128:131], a[128:131], v[232:235], v[128:131]
    buffer_store_dwordx4 v[28:31], v10, s[24:27], s4 offen offset:192 sc1
    v_cvt_pk_bf16_f32 v242, v244, v245
    v_mfma_f32_16x16x32_bf16 v[132:135], a[132:135], v[232:235], v[132:135]
    v_mfma_f32_16x16x32_bf16 v[136:139], a[136:139], v[232:235], v[136:139]
    v_exp_f32 v246, v246
    v_mfma_f32_16x16x32_bf16 v[140:143], a[140:143], v[232:235], v[140:143]
    v_exp_f32 v247, v247
    v_mfma_f32_16x16x32_bf16 v[144:147], a[144:147], v[232:235], v[144:147]
    v_cvt_pk_bf16_f32 v243, v246, v247
    v_mfma_f32_16x16x32_bf16 v[148:151], a[148:151], v[232:235], v[148:151]
    v_mfma_f32_16x16x32_bf16 v[152:155], a[152:155], v[232:235], v[152:155]
    v_mfma_f32_16x16x32_bf16 v[156:159], a[156:159], v[232:235], v[156:159]
    v_mfma_f32_16x16x32_bf16 v[232:235], a[32:35], v[64:67], 0
    v_exp_f32 v224, v224
    v_mfma_f32_16x16x32_bf16 v[232:235], a[36:39], v[68:71], v[232:235]
    v_exp_f32 v225, v225
    v_mfma_f32_16x16x32_bf16 v[232:235], a[40:43], v[72:75], v[232:235]
    ds_read_b128 a[32:35], v0 offset:0
    v_cvt_pk_bf16_f32 v224, v224, v225
    v_mfma_f32_16x16x32_bf16 v[232:235], a[44:47], v[76:79], v[232:235]
    v_exp_f32 v226, v226
    v_mfma_f32_16x16x32_bf16 v[236:239], a[60:63], v[76:79], 0
    v_exp_f32 v227, v227
    v_mfma_f32_16x16x32_bf16 v[236:239], a[56:59], v[72:75], v[236:239]
    ds_read_b128 a[36:39], v0 offset:64
    v_cvt_pk_bf16_f32 v225, v226, v227
    v_mfma_f32_16x16x32_bf16 v[236:239], a[52:55], v[68:71], v[236:239]
    ds_read_b128 a[40:43], v0 offset:128
    ds_read_b128 a[44:47], v0 offset:192
    v_mfma_f32_16x16x32_bf16 v[236:239], a[48:51], v[64:67], v[236:239]
    v_exp_f32 v228, v228
    v_mfma_f32_16x16x32_bf16 a[196:199], a[216:219], v[240:243], a[196:199]
    v_exp_f32 v229, v229
    v_mfma_f32_16x16x32_bf16 v[96:99], a[96:99], v[240:243], v[96:99]
    ds_read_b128 a[48:51], v0 offset:256
    v_cvt_pk_bf16_f32 v226, v228, v229
    v_mfma_f32_16x16x32_bf16 v[100:103], a[100:103], v[240:243], v[100:103]
    ds_read_b128 a[52:55], v0 offset:320
    ds_read_b128 a[56:59], v0 offset:384
    v_mfma_f32_16x16x32_bf16 v[104:107], a[104:107], v[240:243], v[104:107]
    v_exp_f32 v230, v230
    v_mfma_f32_16x16x32_bf16 v[108:111], a[108:111], v[240:243], v[108:111]
    v_exp_f32 v231, v231
    v_mfma_f32_16x16x32_bf16 v[112:115], a[112:115], v[240:243], v[112:115]
    ds_read_b128 a[60:63], v0 offset:448
    v_cvt_pk_bf16_f32 v227, v230, v231
    v_mfma_f32_16x16x32_bf16 v[116:119], a[116:119], v[240:243], v[116:119]
    v_mfma_f32_16x16x32_bf16 v[120:123], a[120:123], v[240:243], v[120:123]
    v_mfma_f32_16x16x32_bf16 v[124:127], a[124:127], v[240:243], v[124:127]
    v_mfma_f32_16x16x32_bf16 v[240:243], a[64:67], v[64:67], 0
    v_exp_f32 v232, v232
    v_mfma_f32_16x16x32_bf16 v[240:243], a[68:71], v[68:71], v[240:243]
    v_exp_f32 v233, v233
    v_mfma_f32_16x16x32_bf16 v[240:243], a[72:75], v[72:75], v[240:243]
    ds_read_b128 a[64:67], v1 offset:0
    v_cvt_pk_bf16_f32 v232, v232, v233
    v_mfma_f32_16x16x32_bf16 v[240:243], a[76:79], v[76:79], v[240:243]
    v_exp_f32 v234, v234
    v_mfma_f32_16x16x32_bf16 v[244:247], a[92:95], v[76:79], 0
    v_exp_f32 v235, v235
    v_mfma_f32_16x16x32_bf16 v[244:247], a[88:91], v[72:75], v[244:247]
    ds_read_b128 a[68:71], v1 offset:64
    v_cvt_pk_bf16_f32 v233, v234, v235
    v_mfma_f32_16x16x32_bf16 v[244:247], a[84:87], v[68:71], v[244:247]
    ds_read_b128 a[72:75], v1 offset:128
    ds_read_b128 a[76:79], v1 offset:192
    v_mfma_f32_16x16x32_bf16 v[244:247], a[80:83], v[64:67], v[244:247]
    v_exp_f32 v236, v236
    v_mfma_f32_16x16x32_bf16 a[196:199], a[216:219], v[224:227], a[196:199]
    v_exp_f32 v237, v237
    v_mfma_f32_16x16x32_bf16 v[96:99], a[128:131], v[224:227], v[96:99]
    ds_read_b128 a[80:83], v1 offset:256
    v_cvt_pk_bf16_f32 v234, v236, v237
    v_mfma_f32_16x16x32_bf16 v[100:103], a[132:135], v[224:227], v[100:103]
    ds_read_b128 a[84:87], v1 offset:320
    ds_read_b128 a[88:91], v1 offset:384
    v_mfma_f32_16x16x32_bf16 v[104:107], a[136:139], v[224:227], v[104:107]
    v_exp_f32 v238, v238
    v_mfma_f32_16x16x32_bf16 v[108:111], a[140:143], v[224:227], v[108:111]
    v_exp_f32 v239, v239
    v_mfma_f32_16x16x32_bf16 v[112:115], a[144:147], v[224:227], v[112:115]
    ds_read_b128 a[92:95], v1 offset:448
    v_cvt_pk_bf16_f32 v235, v238, v239
    v_mfma_f32_16x16x32_bf16 v[116:119], a[148:151], v[224:227], v[116:119]
    v_mfma_f32_16x16x32_bf16 v[120:123], a[152:155], v[224:227], v[120:123]
    v_mfma_f32_16x16x32_bf16 v[124:127], a[156:159], v[224:227], v[124:127]
    v_accvgpr_read_b32 v15, a196
    v_rcp_f32 v14, v15
    v_fmac_f32 v252, 0x75800000, v15
    v_fmac_f32 v253, 0x7c800000, v14
    s_add_u32 s5, s45, 4096
    v_pk_mul_f32 v[96:97], v[96:97], v[14:15] op_sel_hi:[1,0]
    v_pk_mul_f32 v[98:99], v[98:99], v[14:15] op_sel_hi:[1,0]
    v_cvt_pk_bf16_f32 v32, v96, v97
    v_cvt_pk_bf16_f32 v33, v98, v99
    v_pk_fma_f32 v[252:253], v[96:97], v[98:99], v[252:253]
L_pad4:
    s_cbranch_vccnz L_padret
    v_pk_mul_f32 v[100:101], v[100:101], v[14:15] op_sel_hi:[1,0]
    v_pk_mul_f32 v[102:103], v[102:103], v[14:15] op_sel_hi:[1,0]
    v_cvt_pk_bf16_f32 v34, v100, v101
    v_cvt_pk_bf16_f32 v35, v102, v103
    v_pk_fma_f32 v[252:253], v[100:101], v[102:103], v[252:253]
    v_permlane16_swap_b32 v32, v34
    v_permlane16_swap_b32 v33, v35
    v_pk_mul_f32 v[104:105], v[104:105], v[14:15] op_sel_hi:[1,0]
    v_pk_mul_f32 v[106:107], v[106:107], v[14:15] op_sel_hi:[1,0]
    v_cvt_pk_bf16_f32 v36, v104, v105
    v_cvt_pk_bf16_f32 v37, v106, v107
    v_pk_fma_f32 v[252:253], v[104:105], v[106:107], v[252:253]
    v_pk_mul_f32 v[108:109], v[108:109], v[14:15] op_sel_hi:[1,0]
    v_pk_mul_f32 v[110:111], v[110:111], v[14:15] op_sel_hi:[1,0]
    v_cvt_pk_bf16_f32 v38, v108, v109
    v_cvt_pk_bf16_f32 v39, v110, v111
    v_pk_fma_f32 v[252:253], v[108:109], v[110:111], v[252:253]
    v_permlane16_swap_b32 v36, v38
    v_permlane16_swap_b32 v37, v39
    v_pk_mul_f32 v[112:113], v[112:113], v[14:15] op_sel_hi:[1,0]
    v_pk_mul_f32 v[114:115], v[114:115], v[14:15] op_sel_hi:[1,0]
    v_cvt_pk_bf16_f32 v40, v112, v113
    v_cvt_pk_bf16_f32 v41, v114, v115
    v_pk_fma_f32 v[252:253], v[112:113], v[114:115], v[252:253]
    v_pk_mul_f32 v[116:117], v[116:117], v[14:15] op_sel_hi:[1,0]
    v_pk_mul_f32 v[118:119], v[118:119], v[14:15] op_sel_hi:[1,0]
    v_cvt_pk_bf16_f32 v42, v116, v117
    v_cvt_pk_bf16_f32 v43, v118, v119
    v_pk_fma_f32 v[252:253], v[116:117], v[118:119], v[252:253]
    v_permlane16_swap_b32 v40, v42
    v_permlane16_swap_b32 v41, v43
    v_pk_mul_f32 v[120:121], v[120:121], v[14:15] op_sel_hi:[1,0]
    v_pk_mul_f32 v[122:123], v[122:123], v[14:15] op_sel_hi:[1,0]
    v_cvt_pk_bf16_f32 v44, v120, v121
    v_cvt_pk_bf16_f32 v45, v122, v123
    v_pk_fma_f32 v[252:253], v[120:121], v[122:123], v[252:253]
    v_pk_mul_f32 v[124:125], v[124:125], v[14:15] op_sel_hi:[1,0]
    v_pk_mul_f32 v[126:127], v[126:127], v[14:15] op_sel_hi:[1,0]
    v_cvt_pk_bf16_f32 v46, v124, v125
    v_cvt_pk_bf16_f32 v47, v126, v127
    v_pk_fma_f32 v[252:253], v[124:125], v[126:127], v[252:253]
    s_nop 0
    v_permlane16_swap_b32 v44, v46
    v_permlane16_swap_b32 v45, v47
    s_waitcnt lgkmcnt(8)
    v_mfma_f32_16x16x32_bf16 v[224:227], a[32:35], v[48:51], 0
    v_exp_f32 v240, v240
    v_mfma_f32_16x16x32_bf16 v[224:227], a[36:39], v[52:55], v[224:227]
    v_exp_f32 v241, v241
    v_mfma_f32_16x16x32_bf16 v[224:227], a[40:43], v[56:59], v[224:227]
    buffer_store_dwordx4 v[32:35], v10, s[24:27], s5 offen offset:0 sc1
    v_cvt_pk_bf16_f32 v240, v240, v241
    v_mfma_f32_16x16x32_bf16 v[224:227], a[44:47], v[60:63], v[224:227]
    v_exp_f32 v242, v242
    v_mfma_f32_16x16x32_bf16 v[228:231], a[60:63], v[60:63], 0
    v_exp_f32 v243, v243
    v_mfma_f32_16x16x32_bf16 v[228:231], a[56:59], v[56:59], v[228:231]
    v_cvt_pk_bf16_f32 v241, v242, v243
    v_mfma_f32_16x16x32_bf16 v[228:231], a[52:55], v[52:55], v[228:231]
    v_mfma_f32_16x16x32_bf16 v[228:231], a[48:51], v[48:51], v[228:231]
    v_exp_f32 v244, v244
    v_mfma_f32_16x16x32_bf16 a[204:207], a[216:219], v[232:235], a[204:207]
    v_exp_f32 v245, v245
    v_mfma_f32_16x16x32_bf16 v[160:163], a[96:99], v[232:235], v[160:163]
    buffer_store_dwordx4 v[36:39], v10, s[24:27], s5 offen offset:64 sc1
    v_cvt_pk_bf16_f32 v242, v244, v245
    v_mfma_f32_16x16x32_bf16 v[164:167], a[100:103], v[232:235], v[164:167]
    ds_read_b64_tr_b16 a[96:97], v4 offset:0
    ds_read_b64_tr_b16 a[98:99], v4 offset:256
    v_mfma_f32_16x16x32_bf16 v[168:171], a[104:107], v[232:235], v[168:171]
    v_exp_f32 v246, v246
    v_mfma_f32_16x16x32_bf16 v[172:175], a[108:111], v[232:235], v[172:175]
    v_exp_f32 v247, v247
    v_mfma_f32_16x16x32_bf16 v[176:179], a[112:115], v[232:235], v[176:179]
    ds_read_b64_tr_b16 a[100:101], v4 offset:32
    v_cvt_pk_bf16_f32 v243, v246, v247
    v_mfma_f32_16x16x32_bf16 v[180:183], a[116:119], v[232:235], v[180:183]
    ds_read_b64_tr_b16 a[102:103], v4 offset:288
    ds_read_b64_tr_b16 a[104:105], v4 offset:64
    v_mfma_f32_16x16x32_bf16 v[184:187], a[120:123], v[232:235], v[184:187]
    ds_read_b64_tr_b16 a[106:107], v4 offset:320
    ds_read_b64_tr_b16 a[108:109], v4 offset:96
    v_mfma_f32_16x16x32_bf16 v[188:191], a[124:127], v[232:235], v[188:191]
    s_waitcnt lgkmcnt(7)
    buffer_store_dwordx4 v[40:43], v10, s[24:27], s5 offen offset:128 sc1
    ds_read_b64_tr_b16 a[110:111], v4 offset:352
    v_mfma_f32_16x16x32_bf16 v[232:235], a[64:67], v[48:51], 0
    v_exp_f32 v224, v224
    v_mfma_f32_16x16x32_bf16 v[232:235], a[68:71], v[52:55], v[232:235]
    v_exp_f32 v225, v225
    v_mfma_f32_16x16x32_bf16 v[232:235], a[72:75], v[56:59], v[232:235]
    ds_read_b64_tr_b16 a[112:113], v4 offset:128
    v_cvt_pk_bf16_f32 v224, v224, v225
    v_mfma_f32_16x16x32_bf16 v[232:235], a[76:79], v[60:63], v[232:235]
    v_exp_f32 v226, v226
    v_mfma_f32_16x16x32_bf16 v[236:239], a[92:95], v[60:63], 0
    v_exp_f32 v227, v227
    v_mfma_f32_16x16x32_bf16 v[236:239], a[88:91], v[56:59], v[236:239]
    ds_read_b64_tr_b16 a[114:115], v4 offset:384
    v_cvt_pk_bf16_f32 v225, v226, v227
    v_mfma_f32_16x16x32_bf16 v[236:239], a[84:87], v[52:55], v[236:239]
    ds_read_b64_tr_b16 a[116:117], v4 offset:160
    ds_read_b64_tr_b16 a[118:119], v4 offset:416
    v_mfma_f32_16x16x32_bf16 v[236:239], a[80:83], v[48:51], v[236:239]
    v_exp_f32 v228, v228
    v_mfma_f32_16x16x32_bf16 a[204:207], a[216:219], v[240:243], a[204:207]
    v_exp_f32 v229, v229
    v_mfma_f32_16x16x32_bf16 v[160:163], a[128:131], v[240:243], v[160:163]
    buffer_store_dwordx4 v[44:47], v10, s[24:27], s5 offen offset:192 sc1
    v_cvt_pk_bf16_f32 v226, v228, v229
    v_mfma_f32_16x16x32_bf16 v[164:167], a[132:135], v[240:243], v[164:167]
    ds_read_b64_tr_b16 a[120:121], v4 offset:192
    ds_read_b64_tr_b16 a[122:123], v4 offset:448
    v_mfma_f32_16x16x32_bf16 v[168:171], a[136:139], v[240:243], v[168:171]
    v_exp_f32 v230, v230
    v_mfma_f32_16x16x32_bf16 v[172:175], a[140:143], v[240:243], v[172:175]
    v_exp_f32 v231, v231
    v_mfma_f32_16x16x32_bf16 v[176:179], a[144:147], v[240:243], v[176:179]
    ds_read_b64_tr_b16 a[124:125], v4 offset:224
    v_cvt_pk_bf16_f32 v227, v230, v231
    v_mfma_f32_16x16x32_bf16 v[180:183], a[148:151], v[240:243], v[180:183]
    ds_read_b64_tr_b16 a[126:127], v4 offset:480
    ds_read_b64_tr_b16 a[128:129], v5 offset:0
    v_mfma_f32_16x16x32_bf16 v[184:187], a[152:155], v[240:243], v[184:187]
    ds_read_b64_tr_b16 a[130:131], v5 offset:256
    ds_read_b64_tr_b16 a[132:133], v5 offset:32
    v_mfma_f32_16x16x32_bf16 v[188:191], a[156:159], v[240:243], v[188:191]
    ds_read_b64_tr_b16 a[134:135], v5 offset:288
    ds_read_b64_tr_b16 a[136:137], v5 offset:64
    v_mfma_f32_16x16x32_bf16 v[240:243], a[32:35], v[80:83], 0
    v_exp_f32 v232, v232
    v_mfma_f32_16x16x32_bf16 v[240:243], a[36:39], v[84:87], v[240:243]
    v_exp_f32 v233, v233
    v_mfma_f32_16x16x32_bf16 v[240:243], a[40:43], v[88:91], v[240:243]
    ds_read_b64_tr_b16 a[138:139], v5 offset:320
    v_cvt_pk_bf16_f32 v232, v232, v233
    v_mfma_f32_16x16x32_bf16 v[240:243], a[44:47], v[92:95], v[240:243]
    v_exp_f32 v234, v234
    v_mfma_f32_16x16x32_bf16 v[244:247], a[60:63], v[92:95], 0
    v_exp_f32 v235, v235
    v_mfma_f32_16x16x32_bf16 v[244:247], a[56:59], v[88:91], v[244:247]
    ds_read_b64_tr_b16 a[140:141], v5 offset:96
    v_cvt_pk_bf16_f32 v233, v234, v235
    v_mfma_f32_16x16x32_bf16 v[244:247], a[52:55], v[84:87], v[244:247]
    ds_read_b64_tr_b16 a[142:143], v5 offset:352
    ds_read_b64_tr_b16 a[144:145], v5 offset:128
    v_mfma_f32_16x16x32_bf16 v[244:247], a[48:51], v[80:83], v[244:247]
    v_exp_f32 v236, v236
    v_mfma_f32_16x16x32_bf16 a[200:203], a[216:219], v[224:227], a[200:203]
    s_waitcnt lgkmcnt(9)
    v_exp_f32 v237, v237
    v_mfma_f32_16x16x32_bf16 v[128:131], a[96:99], v[224:227], v[128:131]
    ds_read_b64_tr_b16 a[146:147], v5 offset:384
    v_cvt_pk_bf16_f32 v234, v236, v237
    v_mfma_f32_16x16x32_bf16 v[132:135], a[100:103], v[224:227], v[132:135]
    ds_read_b64_tr_b16 a[148:149], v5 offset:160
    ds_read_b64_tr_b16 a[150:151], v5 offset:416
    v_mfma_f32_16x16x32_bf16 v[136:139], a[104:107], v[224:227], v[136:139]
    v_exp_f32 v238, v238
    v_mfma_f32_16x16x32_bf16 v[140:143], a[108:111], v[224:227], v[140:143]
    v_exp_f32 v239, v239
    v_mfma_f32_16x16x32_bf16 v[144:147], a[112:115], v[224:227], v[144:147]
    ds_read_b64_tr_b16 a[152:153], v5 offset:192
    v_cvt_pk_bf16_f32 v235, v238, v239
    v_mfma_f32_16x16x32_bf16 v[148:151], a[116:119], v[224:227], v[148:151]
    ds_read_b64_tr_b16 a[154:155], v5 offset:448
    ds_read_b64_tr_b16 a[156:157], v5 offset:224
    v_mfma_f32_16x16x32_bf16 v[152:155], a[120:123], v[224:227], v[152:155]
    ds_read_b64_tr_b16 a[158:159], v5 offset:480
    v_mfma_f32_16x16x32_bf16 v[156:159], a[124:127], v[224:227], v[156:159]
    v_mfma_f32_16x16x32_bf16 v[224:227], a[64:67], v[80:83], 0
    v_exp_f32 v240, v240
    v_mfma_f32_16x16x32_bf16 v[224:227], a[68:71], v[84:87], v[224:227]
    v_exp_f32 v241, v241
    v_mfma_f32_16x16x32_bf16 v[224:227], a[72:75], v[88:91], v[224:227]
    v_cvt_pk_bf16_f32 v240, v240, v241
    v_mfma_f32_16x16x32_bf16 v[224:227], a[76:79], v[92:95], v[224:227]
    v_exp_f32 v242, v242
    v_mfma_f32_16x16x32_bf16 v[228:231], a[92:95], v[92:95], 0
    v_exp_f32 v243, v243
    v_mfma_f32_16x16x32_bf16 v[228:231], a[88:91], v[88:91], v[228:231]
    v_cvt_pk_bf16_f32 v241, v242, v243
    v_mfma_f32_16x16x32_bf16 v[228:231], a[84:87], v[84:87], v[228:231]
    v_mfma_f32_16x16x32_bf16 v[228:231], a[80:83], v[80:83], v[228:231]
    v_exp_f32 v244, v244
    v_mfma_f32_16x16x32_bf16 a[200:203], a[216:219], v[232:235], a[200:203]
    s_waitcnt lgkmcnt(0)
    v_exp_f32 v245, v245
    v_mfma_f32_16x16x32_bf16 v[128:131], a[128:131], v[232:235], v[128:131]
    v_cvt_pk_bf16_f32 v242, v244, v245
    v_mfma_f32_16x16x32_bf16 v[132:135], a[132:135], v[232:235], v[132:135]
    v_mfma_f32_16x16x32_bf16 v[136:139], a[136:139], v[232:235], v[136:139]
    v_exp_f32 v246, v246
    v_mfma_f32_16x16x32_bf16 v[140:143], a[140:143], v[232:235], v[140:143]
    v_exp_f32 v247, v247
    v_mfma_f32_16x16x32_bf16 v[144:147], a[144:147], v[232:235], v[144:147]
    v_cvt_pk_bf16_f32 v243, v246, v247
    v_mfma_f32_16x16x32_bf16 v[148:151], a[148:151], v[232:235], v[148:151]
    v_mfma_f32_16x16x32_bf16 v[152:155], a[152:155], v[232:235], v[152:155]
    v_mfma_f32_16x16x32_bf16 v[156:159], a[156:159], v[232:235], v[156:159]
    v_accvgpr_read_b32 v15, a200
    v_rcp_f32 v14, v15
    v_fmac_f32 v252, 0x75800000, v15
    v_fmac_f32 v253, 0x7c800000, v14
    s_add_u32 s6, s45, 8192
    v_pk_mul_f32 v[128:129], v[128:129], v[14:15] op_sel_hi:[1,0]
    v_pk_mul_f32 v[130:131], v[130:131], v[14:15] op_sel_hi:[1,0]
    v_cvt_pk_bf16_f32 v48, v128, v129
    v_cvt_pk_bf16_f32 v49, v130, v131
    v_pk_fma_f32 v[252:253], v[128:129], v[130:131], v[252:253]
    v_pk_mul_f32 v[132:133], v[132:133], v[14:15] op_sel_hi:[1,0]
    v_pk_mul_f32 v[134:135], v[134:135], v[14:15] op_sel_hi:[1,0]
    v_cvt_pk_bf16_f32 v50, v132, v133
    v_cvt_pk_bf16_f32 v51, v134, v135
    v_pk_fma_f32 v[252:253], v[132:133], v[134:135], v[252:253]
    v_permlane16_swap_b32 v48, v50
    v_permlane16_swap_b32 v49, v51
    v_pk_mul_f32 v[136:137], v[136:137], v[14:15] op_sel_hi:[1,0]
    v_pk_mul_f32 v[138:139], v[138:139], v[14:15] op_sel_hi:[1,0]
    v_cvt_pk_bf16_f32 v52, v136, v137
    v_cvt_pk_bf16_f32 v53, v138, v139
    v_pk_fma_f32 v[252:253], v[136:137], v[138:139], v[252:253]
    v_pk_mul_f32 v[140:141], v[140:141], v[14:15] op_sel_hi:[1,0]
    v_pk_mul_f32 v[142:143], v[142:143], v[14:15] op_sel_hi:[1,0]
    v_cvt_pk_bf16_f32 v54, v140, v141
    v_cvt_pk_bf16_f32 v55, v142, v143
    v_pk_fma_f32 v[252:253], v[140:141], v[142:143], v[252:253]
    v_permlane16_swap_b32 v52, v54
    v_permlane16_swap_b32 v53, v55
    v_pk_mul_f32 v[144:145], v[144:145], v[14:15] op_sel_hi:[1,0]
    v_pk_mul_f32 v[146:147], v[146:147], v[14:15] op_sel_hi:[1,0]
    v_cvt_pk_bf16_f32 v56, v144, v145
    v_cvt_pk_bf16_f32 v57, v146, v147
    v_pk_fma_f32 v[252:253], v[144:145], v[146:147], v[252:253]
    v_pk_mul_f32 v[148:149], v[148:149], v[14:15] op_sel_hi:[1,0]
    v_pk_mul_f32 v[150:151], v[150:151], v[14:15] op_sel_hi:[1,0]
    v_cvt_pk_bf16_f32 v58, v148, v149
    v_cvt_pk_bf16_f32 v59, v150, v151
    v_pk_fma_f32 v[252:253], v[148:149], v[150:151], v[252:253]
    v_permlane16_swap_b32 v56, v58
    v_permlane16_swap_b32 v57, v59
    v_pk_mul_f32 v[152:153], v[152:153], v[14:15] op_sel_hi:[1,0]
    v_pk_mul_f32 v[154:155], v[154:155], v[14:15] op_sel_hi:[1,0]
    v_cvt_pk_bf16_f32 v60, v152, v153
    v_cvt_pk_bf16_f32 v61, v154, v155
    v_pk_fma_f32 v[252:253], v[152:153], v[154:155], v[252:253]
    v_pk_mul_f32 v[156:157], v[156:157], v[14:15] op_sel_hi:[1,0]
    v_pk_mul_f32 v[158:159], v[158:159], v[14:15] op_sel_hi:[1,0]
    v_cvt_pk_bf16_f32 v62, v156, v157
    v_cvt_pk_bf16_f32 v63, v158, v159
    v_pk_fma_f32 v[252:253], v[156:157], v[158:159], v[252:253]
    s_nop 0
    v_permlane16_swap_b32 v60, v62
    v_permlane16_swap_b32 v61, v63
    v_mfma_f32_16x16x32_bf16 v[232:235], a[32:35], v[64:67], 0
    v_exp_f32 v224, v224
    v_mfma_f32_16x16x32_bf16 v[232:235], a[36:39], v[68:71], v[232:235]
    v_exp_f32 v225, v225
    v_mfma_f32_16x16x32_bf16 v[232:235], a[40:43], v[72:75], v[232:235]
    buffer_store_dwordx4 v[48:51], v10, s[24:27], s6 offen offset:0 sc1
    v_cvt_pk_bf16_f32 v224, v224, v225
    v_mfma_f32_16x16x32_bf16 v[232:235], a[44:47], v[76:79], v[232:235]
    v_exp_f32 v226, v226
    v_mfma_f32_16x16x32_bf16 v[236:239], a[60:63], v[76:79], 0
    v_exp_f32 v227, v227
    v_mfma_f32_16x16x32_bf16 v[236:239], a[56:59], v[72:75], v[236:239]
    ds_read_b128 a[32:35], v2 offset:0
    v_cvt_pk_bf16_f32 v225, v226, v227
    v_mfma_f32_16x16x32_bf16 v[236:239], a[52:55], v[68:71], v[236:239]
    ds_read_b128 a[36:39], v2 offset:64
    ds_read_b128 a[40:43], v2 offset:128
    v_mfma_f32_16x16x32_bf16 v[236:239], a[48:51], v[64:67], v[236:239]
    v_exp_f32 v228, v228
    v_mfma_f32_16x16x32_bf16 a[208:211], a[216:219], v[240:243], a[208:211]
    v_exp_f32 v229, v229
    v_mfma_f32_16x16x32_bf16 v[192:195], a[96:99], v[240:243], v[192:195]
    buffer_store_dwordx4 v[52:55], v10, s[24:27], s6 offen offset:64 sc1
    v_cvt_pk_bf16_f32 v226, v228, v229
    v_mfma_f32_16x16x32_bf16 v[196:199], a[100:103], v[240:243], v[196:199]
    ds_read_b128 a[44:47], v2 offset:192
    ds_read_b128 a[48:51], v2 offset:256
    v_mfma_f32_16x16x32_bf16 v[200:203], a[104:107], v[240:243], v[200:203]
    v_exp_f32 v230, v230
    v_mfma_f32_16x16x32_bf16 v[204:207], a[108:111], v[240:243], v[204:207]
    v_exp_f32 v231, v231
    v_mfma_f32_16x16x32_bf16 v[208:211], a[112:115], v[240:243], v[208:211]
    ds_read_b128 a[52:55], v2 offset:320
    v_cvt_pk_bf16_f32 v227, v230, v231
    v_mfma_f32_16x16x32_bf16 v[212:215], a[116:119], v[240:243], v[212:215]
    ds_read_b128 a[56:59], v2 offset:384
    ds_read_b128 a[60:63], v2 offset:448
    v_mfma_f32_16x16x32_bf16 v[216:219], a[120:123], v[240:243], v[216:219]
    v_mfma_f32_16x16x32_bf16 v[220:223], a[124:127], v[240:243], v[220:223]
    buffer_store_dwordx4 v[56:59], v10, s[24:27], s6 offen offset:128 sc1
    v_mfma_f32_16x16x32_bf16 v[240:243], a[64:67], v[64:67], 0
    v_exp_f32 v232, v232
    v_mfma_f32_16x16x32_bf16 v[240:243], a[68:71], v[68:71], v[240:243]
    v_exp_f32 v233, v233
    v_mfma_f32_16x16x32_bf16 v[240:243], a[72:75], v[72:75], v[240:243]
    ds_read_b128 a[64:67], v3 offset:0
    v_cvt_pk_bf16_f32 v232, v232, v233
    v_mfma_f32_16x16x32_bf16 v[240:243], a[76:79], v[76:79], v[240:243]
    v_exp_f32 v234, v234
    v_mfma_f32_16x16x32_bf16 v[244:247], a[92:95], v[76:79], 0
    v_exp_f32 v235, v235
    v_mfma_f32_16x16x32_bf16 v[244:247], a[88:91], v[72:75], v[244:247]
    ds_read_b128 a[68:71], v3 offset:64
    v_cvt_pk_bf16_f32 v233, v234, v235
    v_mfma_f32_16x16x32_bf16 v[244:247], a[84:87], v[68:71], v[244:247]
    ds_read_b128 a[72:75], v3 offset:128
    ds_read_b128 a[76:79], v3 offset:192
    v_mfma_f32_16x16x32_bf16 v[244:247], a[80:83], v[64:67], v[244:247]
    v_exp_f32 v236, v236
    v_mfma_f32_16x16x32_bf16 a[208:211], a[216:219], v[224:227], a[208:211]
    v_exp_f32 v237, v237
    v_mfma_f32_16x16x32_bf16 v[192:195], a[128:131], v[224:227], v[192:195]
    buffer_store_dwordx4 v[60:63], v10, s[24:27], s6 offen offset:192 sc1
    v_cvt_pk_bf16_f32 v234, v236, v237
    v_mfma_f32_16x16x32_bf16 v[196:199], a[132:135], v[224:227], v[196:199]
    ds_read_b128 a[80:83], v3 offset:256
    ds_read_b128 a[84:87], v3 offset:320
    v_mfma_f32_16x16x32_bf16 v[200:203], a[136:139], v[224:227], v[200:203]
    v_exp_f32 v238, v238
    v_mfma_f32_16x16x32_bf16 v[204:207], a[140:143], v[224:227], v[204:207]
    v_exp_f32 v239, v239
    v_mfma_f32_16x16x32_bf16 v[208:211], a[144:147], v[224:227], v[208:211]
    ds_read_b128 a[88:91], v3 offset:384
    v_cvt_pk_bf16_f32 v235, v238, v239
    v_mfma_f32_16x16x32_bf16 v[212:215], a[148:151], v[224:227], v[212:215]
    ds_read_b128 a[92:95], v3 offset:448
    v_mfma_f32_16x16x32_bf16 v[216:219], a[152:155], v[224:227], v[216:219]
    v_mfma_f32_16x16x32_bf16 v[220:223], a[156:159], v[224:227], v[220:223]
    s_waitcnt lgkmcnt(8)
    v_mfma_f32_16x16x32_bf16 v[224:227], a[32:35], v[80:83], 0
    v_exp_f32 v240, v240
    v_mfma_f32_16x16x32_bf16 v[224:227], a[36:39], v[84:87], v[224:227]
    v_exp_f32 v241, v241
    v_mfma_f32_16x16x32_bf16 v[224:227], a[40:43], v[88:91], v[224:227]
    v_cvt_pk_bf16_f32 v240, v240, v241
    v_mfma_f32_16x16x32_bf16 v[224:227], a[44:47], v[92:95], v[224:227]
    v_exp_f32 v242, v242
    v_mfma_f32_16x16x32_bf16 v[228:231], a[60:63], v[92:95], 0
    v_exp_f32 v243, v243
    v_mfma_f32_16x16x32_bf16 v[228:231], a[56:59], v[88:91], v[228:231]
    v_cvt_pk_bf16_f32 v241, v242, v243
    v_mfma_f32_16x16x32_bf16 v[228:231], a[52:55], v[84:87], v[228:231]
    v_mfma_f32_16x16x32_bf16 v[228:231], a[48:51], v[80:83], v[228:231]
    v_exp_f32 v244, v244
    v_mfma_f32_16x16x32_bf16 a[204:207], a[216:219], v[232:235], a[204:207]
    v_exp_f32 v245, v245
    v_mfma_f32_16x16x32_bf16 v[160:163], a[96:99], v[232:235], v[160:163]
    ds_read_b64_tr_b16 a[96:97], v6 offset:0
    v_cvt_pk_bf16_f32 v242, v244, v245
    v_mfma_f32_16x16x32_bf16 v[164:167], a[100:103], v[232:235], v[164:167]
    ds_read_b64_tr_b16 a[98:99], v6 offset:256
    ds_read_b64_tr_b16 a[100:101], v6 offset:32
    v_mfma_f32_16x16x32_bf16 v[168:171], a[104:107], v[232:235], v[168:171]
    v_exp_f32 v246, v246
    v_mfma_f32_16x16x32_bf16 v[172:175], a[108:111], v[232:235], v[172:175]
    v_exp_f32 v247, v247
    v_mfma_f32_16x16x32_bf16 v[176:179], a[112:115], v[232:235], v[176:179]
    ds_read_b64_tr_b16 a[102:103], v6 offset:288
    v_cvt_pk_bf16_f32 v243, v246, v247
    v_mfma_f32_16x16x32_bf16 v[180:183], a[116:119], v[232:235], v[180:183]
    ds_read_b64_tr_b16 a[104:105], v6 offset:64
    ds_read_b64_tr_b16 a[106:107], v6 offset:320
    v_mfma_f32_16x16x32_bf16 v[184:187], a[120:123], v[232:235], v[184:187]
    ds_read_b64_tr_b16 a[108:109], v6 offset:96
    ds_read_b64_tr_b16 a[110:111], v6 offset:352
    v_mfma_f32_16x16x32_bf16 v[188:191], a[124:127], v[232:235], v[188:191]
    ds_read_b64_tr_b16 a[112:113], v6 offset:128
    ds_read_b64_tr_b16 a[114:115], v6 offset:384
    v_mfma_f32_16x16x32_bf16 v[232:235], a[32:35], a[220:223], 0
    v_exp_f32 v224, v224
    v_mfma_f32_16x16x32_bf16 v[232:235], a[36:39], a[224:227], v[232:235]
    v_exp_f32 v225, v225
    v_mfma_f32_16x16x32_bf16 v[232:235], a[40:43], a[228:231], v[232:235]
    ds_read_b64_tr_b16 a[116:117], v6 offset:160
    v_cvt_pk_bf16_f32 v224, v224, v225
    v_mfma_f32_16x16x32_bf16 v[232:235], a[44:47], a[232:235], v[232:235]
    v_exp_f32 v226, v226
    v_mfma_f32_16x16x32_bf16 v[236:239], a[60:63], a[232:235], 0
    v_exp_f32 v227, v227
    v_mfma_f32_16x16x32_bf16 v[236:239], a[56:59], a[228:231], v[236:239]
    ds_read_b64_tr_b16 a[118:119], v6 offset:416
    v_cvt_pk_bf16_f32 v225, v226, v227
    v_mfma_f32_16x16x32_bf16 v[236:239], a[52:55], a[224:227], v[236:239]
    ds_read_b64_tr_b16 a[120:121], v6 offset:192
    ds_read_b64_tr_b16 a[122:123], v6 offset:448
    v_mfma_f32_16x16x32_bf16 v[236:239], a[48:51], a[220:223], v[236:239]
    v_exp_f32 v228, v228
    v_mfma_f32_16x16x32_bf16 a[204:207], a[216:219], v[240:243], a[204:207]
    v_exp_f32 v229, v229
    v_mfma_f32_16x16x32_bf16 v[160:163], a[128:131], v[240:243], v[160:163]
    ds_read_b64_tr_b16 a[124:125], v6 offset:224
    v_cvt_pk_bf16_f32 v226, v228, v229
    v_mfma_f32_16x16x32_bf16 v[164:167], a[132:135], v[240:243], v[164:167]
    ds_read_b64_tr_b16 a[126:127], v6 offset:480
    ds_read_b64_tr_b16 a[128:129], v7 offset:0
    v_mfma_f32_16x16x32_bf16 v[168:171], a[136:139], v[240:243], v[168:171]
    v_exp_f32 v230, v230
    v_mfma_f32_16x16x32_bf16 v[172:175], a[140:143], v[240:243], v[172:175]
    v_exp_f32 v231, v231
    v_mfma_f32_16x16x32_bf16 v[176:179], a[144:147], v[240:243], v[176:179]
    ds_read_b64_tr_b16 a[130:131], v7 offset:256
    v_cvt_pk_bf16_f32 v227, v230, v231
    v_mfma_f32_16x16x32_bf16 v[180:183], a[148:151], v[240:243], v[180:183]
    ds_read_b64_tr_b16 a[132:133], v7 offset:32
    ds_read_b64_tr_b16 a[134:135], v7 offset:288
    v_mfma_f32_16x16x32_bf16 v[184:187], a[152:155], v[240:243], v[184:187]
    ds_read_b64_tr_b16 a[136:137], v7 offset:64
    ds_read_b64_tr_b16 a[138:139], v7 offset:320
    v_mfma_f32_16x16x32_bf16 v[188:191], a[156:159], v[240:243], v[188:191]
    ds_read_b64_tr_b16 a[140:141], v7 offset:96
    ds_read_b64_tr_b16 a[142:143], v7 offset:352
    v_accvgpr_read_b32 v15, a204
    v_rcp_f32 v14, v15
    v_fmac_f32 v252, 0x75800000, v15
    v_fmac_f32 v253, 0x7c800000, v14
    s_add_u32 s7, s45, 12288
    v_pk_mul_f32 v[160:161], v[160:161], v[14:15] op_sel_hi:[1,0]
    v_pk_mul_f32 v[162:163], v[162:163], v[14:15] op_sel_hi:[1,0]
    v_cvt_pk_bf16_f32 v64, v160, v161
    v_cvt_pk_bf16_f32 v65, v162, v163
    v_pk_fma_f32 v[252:253], v[160:161], v[162:163], v[252:253]
    v_pk_mul_f32 v[164:165], v[164:165], v[14:15] op_sel_hi:[1,0]
    v_pk_mul_f32 v[166:167], v[166:167], v[14:15] op_sel_hi:[1,0]
    v_cvt_pk_bf16_f32 v66, v164, v165
    v_cvt_pk_bf16_f32 v67, v166, v167
    v_pk_fma_f32 v[252:253], v[164:165], v[166:167], v[252:253]
    v_permlane16_swap_b32 v64, v66
    v_permlane16_swap_b32 v65, v67
    v_pk_mul_f32 v[168:169], v[168:169], v[14:15] op_sel_hi:[1,0]
    v_pk_mul_f32 v[170:171], v[170:171], v[14:15] op_sel_hi:[1,0]
    v_cvt_pk_bf16_f32 v68, v168, v169
    v_cvt_pk_bf16_f32 v69, v170, v171
    v_pk_fma_f32 v[252:253], v[168:169], v[170:171], v[252:253]
    v_pk_mul_f32 v[172:173], v[172:173], v[14:15] op_sel_hi:[1,0]
    v_pk_mul_f32 v[174:175], v[174:175], v[14:15] op_sel_hi:[1,0]
    v_cvt_pk_bf16_f32 v70, v172, v173
    v_cvt_pk_bf16_f32 v71, v174, v175
    v_pk_fma_f32 v[252:253], v[172:173], v[174:175], v[252:253]
    v_permlane16_swap_b32 v68, v70
    v_permlane16_swap_b32 v69, v71
    v_pk_mul_f32 v[176:177], v[176:177], v[14:15] op_sel_hi:[1,0]
    v_pk_mul_f32 v[178:179], v[178:179], v[14:15] op_sel_hi:[1,0]
    v_cvt_pk_bf16_f32 v72, v176, v177
    v_cvt_pk_bf16_f32 v73, v178, v179
    v_pk_fma_f32 v[252:253], v[176:177], v[178:179], v[252:253]
    v_pk_mul_f32 v[180:181], v[180:181], v[14:15] op_sel_hi:[1,0]
    v_pk_mul_f32 v[182:183], v[182:183], v[14:15] op_sel_hi:[1,0]
    v_cvt_pk_bf16_f32 v74, v180, v181
    v_cvt_pk_bf16_f32 v75, v182, v183
    v_pk_fma_f32 v[252:253], v[180:181], v[182:183], v[252:253]
    v_permlane16_swap_b32 v72, v74
    v_permlane16_swap_b32 v73, v75
    v_pk_mul_f32 v[184:185], v[184:185], v[14:15] op_sel_hi:[1,0]
    v_pk_mul_f32 v[186:187], v[186:187], v[14:15] op_sel_hi:[1,0]
    v_cvt_pk_bf16_f32 v76, v184, v185
    v_cvt_pk_bf16_f32 v77, v186, v187
    v_pk_fma_f32 v[252:253], v[184:185], v[186:187], v[252:253]
    v_pk_mul_f32 v[188:189], v[188:189], v[14:15] op_sel_hi:[1,0]
    v_pk_mul_f32 v[190:191], v[190:191], v[14:15] op_sel_hi:[1,0]
    v_cvt_pk_bf16_f32 v78, v188, v189
    v_cvt_pk_bf16_f32 v79, v190, v191
    v_pk_fma_f32 v[252:253], v[188:189], v[190:191], v[252:253]
    s_nop 0
    v_permlane16_swap_b32 v76, v78
    v_permlane16_swap_b32 v77, v79
    s_waitcnt lgkmcnt(15)
    v_mfma_f32_16x16x32_bf16 v[240:243], a[64:67], v[80:83], 0
    v_exp_f32 v232, v232
    v_mfma_f32_16x16x32_bf16 v[240:243], a[68:71], v[84:87], v[240:243]
    v_exp_f32 v233, v233
    v_mfma_f32_16x16x32_bf16 v[240:243], a[72:75], v[88:91], v[240:243]
    buffer_store_dwordx4 v[64:67], v10, s[24:27], s7 offen offset:0 sc1
    v_cvt_pk_bf16_f32 v232, v232, v233
    v_mfma_f32_16x16x32_bf16 v[240:243], a[76:79], v[92:95], v[240:243]
    v_exp_f32 v234, v234
    v_mfma_f32_16x16x32_bf16 v[244:247], a[92:95], v[92:95], 0
    v_exp_f32 v235, v235
    v_mfma_f32_16x16x32_bf16 v[244:247], a[88:91], v[88:91], v[244:247]
    ds_read_b64_tr_b16 a[144:145], v7 offset:128
    v_cvt_pk_bf16_f32 v233, v234, v235
    v_mfma_f32_16x16x32_bf16 v[244:247], a[84:87], v[84:87], v[244:247]
    ds_read_b64_tr_b16 a[146:147], v7 offset:384
    ds_read_b64_tr_b16 a[148:149], v7 offset:160
    v_mfma_f32_16x16x32_bf16 v[244:247], a[80:83], v[80:83], v[244:247]
    v_exp_f32 v236, v236
    v_mfma_f32_16x16x32_bf16 a[208:211], a[216:219], v[224:227], a[208:211]
    s_waitcnt lgkmcnt(11)
    v_exp_f32 v237, v237
    v_mfma_f32_16x16x32_bf16 v[192:195], a[96:99], v[224:227], v[192:195]
    buffer_store_dwordx4 v[68:71], v10, s[24:27], s7 offen offset:64 sc1
    v_cvt_pk_bf16_f32 v234, v236, v237
    v_mfma_f32_16x16x32_bf16 v[196:199], a[100:103], v[224:227], v[196:199]
    ds_read_b64_tr_b16 a[150:151], v7 offset:416
    ds_read_b64_tr_b16 a[152:153], v7 offset:192
    v_mfma_f32_16x16x32_bf16 v[200:203], a[104:107], v[224:227], v[200:203]
    v_exp_f32 v238, v238
    v_mfma_f32_16x16x32_bf16 v[204:207], a[108:111], v[224:227], v[204:207]
    v_exp_f32 v239, v239
    v_mfma_f32_16x16x32_bf16 v[208:211], a[112:115], v[224:227], v[208:211]
    ds_read_b64_tr_b16 a[154:155], v7 offset:448
    v_cvt_pk_bf16_f32 v235, v238, v239
    v_mfma_f32_16x16x32_bf16 v[212:215], a[116:119], v[224:227], v[212:215]
    ds_read_b64_tr_b16 a[156:157], v7 offset:224
    ds_read_b64_tr_b16 a[158:159], v7 offset:480
    v_mfma_f32_16x16x32_bf16 v[216:219], a[120:123], v[224:227], v[216:219]
    v_mfma_f32_16x16x32_bf16 v[220:223], a[124:127], v[224:227], v[220:223]
    buffer_store_dwordx4 v[72:75], v10, s[24:27], s7 offen offset:128 sc1
    v_mfma_f32_16x16x32_bf16 a[212:215], a[216:219], v[232:235], a[212:215]
    v_exp_f32 v240, v240
    v_mfma_f32_16x16x32_bf16 a[160:163], a[96:99], v[232:235], a[160:163]
    v_exp_f32 v241, v241
    v_mfma_f32_16x16x32_bf16 a[164:167], a[100:103], v[232:235], a[164:167]
    v_cvt_pk_bf16_f32 v240, v240, v241
    v_exp_f32 v242, v242
    v_mfma_f32_16x16x32_bf16 a[168:171], a[104:107], v[232:235], a[168:171]
    v_exp_f32 v243, v243
    v_mfma_f32_16x16x32_bf16 a[172:175], a[108:111], v[232:235], a[172:175]
    v_cvt_pk_bf16_f32 v241, v242, v243
    v_exp_f32 v244, v244
    v_mfma_f32_16x16x32_bf16 a[176:179], a[112:115], v[232:235], a[176:179]
    v_exp_f32 v245, v245
    v_mfma_f32_16x16x32_bf16 a[180:183], a[116:119], v[232:235], a[180:183]
    v_cvt_pk_bf16_f32 v242, v244, v245
    v_exp_f32 v246, v246
    v_mfma_f32_16x16x32_bf16 a[184:187], a[120:123], v[232:235], a[184:187]
    v_exp_f32 v247, v247
    v_mfma_f32_16x16x32_bf16 a[188:191], a[124:127], v[232:235], a[188:191]
    buffer_store_dwordx4 v[76:79], v10, s[24:27], s7 offen offset:192 sc1
    v_cvt_pk_bf16_f32 v243, v246, v247
    s_nop 1
    s_mul_i32 s36, s28, 8448
    s_movk_i32 s37, 33
    v_and_b32 v11, 0xf0, v255
    v_mul_u32_u24 v11, s37, v11
    v_add_u32 v13, s36, v11
    v_lshrrev_b32 v12, 8, v255
    v_lshl_add_u32 v11, v12, 4, v13
    v_mfma_f32_16x16x32_bf16 a[208:211], a[216:219], v[240:243], a[208:211]
    s_waitcnt lgkmcnt(0)
    ds_write_b32 v13, a212 offset:512
    ds_write_b128 v11, a[160:163] offset:0
    v_mfma_f32_16x16x32_bf16 v[192:195], a[128:131], v[240:243], v[192:195]
    ds_write_b128 v11, a[164:167] offset:64
    ds_write_b128 v11, a[168:171] offset:128
    v_mfma_f32_16x16x32_bf16 v[196:199], a[132:135], v[240:243], v[196:199]
    ds_write_b128 v11, a[172:175] offset:192
    ds_write_b128 v11, a[176:179] offset:256
    v_mfma_f32_16x16x32_bf16 v[200:203], a[136:139], v[240:243], v[200:203]
    ds_write_b128 v11, a[180:183] offset:320
    v_mfma_f32_16x16x32_bf16 v[204:207], a[140:143], v[240:243], v[204:207]
    ds_write_b128 v11, a[184:187] offset:384
    v_mfma_f32_16x16x32_bf16 v[208:211], a[144:147], v[240:243], v[208:211]
    ds_write_b128 v11, a[188:191] offset:448
    v_mfma_f32_16x16x32_bf16 v[212:215], a[148:151], v[240:243], v[212:215]
    v_mfma_f32_16x16x32_bf16 v[216:219], a[152:155], v[240:243], v[216:219]
    v_mfma_f32_16x16x32_bf16 v[220:223], a[156:159], v[240:243], v[220:223]
    v_accvgpr_read_b32 v15, a208
    v_rcp_f32 v14, v15
    v_fmac_f32 v252, 0x75800000, v15
    v_fmac_f32 v253, 0x7c800000, v14
    s_add_u32 s8, s45, 16384
    v_pk_mul_f32 v[192:193], v[192:193], v[14:15] op_sel_hi:[1,0]
    v_pk_mul_f32 v[194:195], v[194:195], v[14:15] op_sel_hi:[1,0]
    v_cvt_pk_bf16_f32 v80, v192, v193
    v_cvt_pk_bf16_f32 v81, v194, v195
    v_pk_fma_f32 v[252:253], v[192:193], v[194:195], v[252:253]
    v_pk_mul_f32 v[196:197], v[196:197], v[14:15] op_sel_hi:[1,0]
    v_pk_mul_f32 v[198:199], v[198:199], v[14:15] op_sel_hi:[1,0]
    v_cvt_pk_bf16_f32 v82, v196, v197
L_pad5:
    s_cbranch_vccnz L_padret
    v_cvt_pk_bf16_f32 v83, v198, v199
    v_pk_fma_f32 v[252:253], v[196:197], v[198:199], v[252:253]
    v_permlane16_swap_b32 v80, v82
    v_permlane16_swap_b32 v81, v83
    buffer_store_dwordx4 v[80:83], v10, s[24:27], s8 offen offset:0 sc1
    v_pk_mul_f32 v[200:201], v[200:201], v[14:15] op_sel_hi:[1,0]
    v_pk_mul_f32 v[202:203], v[202:203], v[14:15] op_sel_hi:[1,0]
    v_cvt_pk_bf16_f32 v84, v200, v201
    v_cvt_pk_bf16_f32 v85, v202, v203
    v_pk_fma_f32 v[252:253], v[200:201], v[202:203], v[252:253]
    v_pk_mul_f32 v[204:205], v[204:205], v[14:15] op_sel_hi:[1,0]
    v_pk_mul_f32 v[206:207], v[206:207], v[14:15] op_sel_hi:[1,0]
    v_cvt_pk_bf16_f32 v86, v204, v205
    v_cvt_pk_bf16_f32 v87, v206, v207
    v_pk_fma_f32 v[252:253], v[204:205], v[206:207], v[252:253]
    v_permlane16_swap_b32 v84, v86
    v_permlane16_swap_b32 v85, v87
    buffer_store_dwordx4 v[84:87], v10, s[24:27], s8 offen offset:64 sc1
    v_pk_mul_f32 v[208:209], v[208:209], v[14:15] op_sel_hi:[1,0]
    v_pk_mul_f32 v[210:211], v[210:211], v[14:15] op_sel_hi:[1,0]
    v_cvt_pk_bf16_f32 v88, v208, v209
    v_cvt_pk_bf16_f32 v89, v210, v211
    v_pk_fma_f32 v[252:253], v[208:209], v[210:211], v[252:253]
    v_pk_mul_f32 v[212:213], v[212:213], v[14:15] op_sel_hi:[1,0]
    v_pk_mul_f32 v[214:215], v[214:215], v[14:15] op_sel_hi:[1,0]
    v_cvt_pk_bf16_f32 v90, v212, v213
    v_cvt_pk_bf16_f32 v91, v214, v215
    v_pk_fma_f32 v[252:253], v[212:213], v[214:215], v[252:253]
    v_permlane16_swap_b32 v88, v90
    v_permlane16_swap_b32 v89, v91
    buffer_store_dwordx4 v[88:91], v10, s[24:27], s8 offen offset:128 sc1
    v_pk_mul_f32 v[216:217], v[216:217], v[14:15] op_sel_hi:[1,0]
    v_pk_mul_f32 v[218:219], v[218:219], v[14:15] op_sel_hi:[1,0]
    v_cvt_pk_bf16_f32 v92, v216, v217
    v_cvt_pk_bf16_f32 v93, v218, v219
    v_pk_fma_f32 v[252:253], v[216:217], v[218:219], v[252:253]
    v_pk_mul_f32 v[220:221], v[220:221], v[14:15] op_sel_hi:[1,0]
    v_pk_mul_f32 v[222:223], v[222:223], v[14:15] op_sel_hi:[1,0]
    v_cvt_pk_bf16_f32 v94, v220, v221
    v_cvt_pk_bf16_f32 v95, v222, v223
    v_pk_fma_f32 v[252:253], v[220:221], v[222:223], v[252:253]
    s_nop 0
    v_permlane16_swap_b32 v92, v94
    v_permlane16_swap_b32 v93, v95
    buffer_store_dwordx4 v[92:95], v10, s[24:27], s8 offen offset:192 sc1
    s_mul_i32 s36, s28, 2112
    s_movk_i32 s37, 528
    v_mul_u32_u24 v13, s37, v12
    v_add_u32 v13, s36, v13
    v_and_b32 v11, 0xf0, v255
    v_lshl_add_u32 v11, v11, 1, v13
    s_waitcnt lgkmcnt(0)
    s_barrier
    ds_read_b32 v248, v13 offset:512
    ds_read_b32 v249, v13 offset:8960
    ds_read_b32 v250, v13 offset:17408
    ds_read_b32 v251, v13 offset:25856
    ds_read_b128 v[16:19], v11 offset:0
    ds_read_b128 v[20:23], v11 offset:16
    ds_read_b128 v[24:27], v11 offset:8448
    ds_read_b128 v[28:31], v11 offset:8464
    ds_read_b128 v[32:35], v11 offset:16896
    ds_read_b128 v[36:39], v11 offset:16912
    ds_read_b128 v[40:43], v11 offset:25344
    ds_read_b128 v[44:47], v11 offset:25360
    s_lshl_b32 s41, s28, 10
    s_add_u32 s41, s41, 81920
    s_waitcnt lgkmcnt(0)
    v_pk_add_f32 v[248:249], v[248:249], v[250:251]
    v_pk_add_f32 v[16:17], v[16:17], v[24:25]
    v_pk_add_f32 v[18:19], v[18:19], v[26:27]
    v_pk_add_f32 v[20:21], v[20:21], v[28:29]
    v_pk_add_f32 v[22:23], v[22:23], v[30:31]
    v_add_f32 v248, v248, v249
    v_pk_add_f32 v[32:33], v[32:33], v[40:41]
    v_pk_add_f32 v[34:35], v[34:35], v[42:43]
    v_pk_add_f32 v[36:37], v[36:37], v[44:45]
    v_pk_add_f32 v[38:39], v[38:39], v[46:47]
    v_rcp_f32 v14, v248
    v_pk_add_f32 v[16:17], v[16:17], v[32:33]
    v_pk_add_f32 v[18:19], v[18:19], v[34:35]
    v_pk_add_f32 v[20:21], v[20:21], v[36:37]
    v_pk_add_f32 v[22:23], v[22:23], v[38:39]
    v_fmac_f32 v252, 0x75800000, v248
    v_fmac_f32 v253, 0x7c800000, v14
    v_pk_mul_f32 v[16:17], v[16:17], v[14:15] op_sel_hi:[1,0]
    v_pk_mul_f32 v[18:19], v[18:19], v[14:15] op_sel_hi:[1,0]
    v_pk_mul_f32 v[20:21], v[20:21], v[14:15] op_sel_hi:[1,0]
    v_pk_mul_f32 v[22:23], v[22:23], v[14:15] op_sel_hi:[1,0]
    v_cvt_pk_bf16_f32 v24, v16, v17
    v_cvt_pk_bf16_f32 v25, v18, v19
    v_cvt_pk_bf16_f32 v26, v20, v21
    v_cvt_pk_bf16_f32 v27, v22, v23
    v_pk_fma_f32 v[252:253], v[16:17], v[18:19], v[252:253]
    v_pk_fma_f32 v[252:253], v[20:21], v[22:23], v[252:253]
    buffer_store_dwordx4 v[24:27], v255, s[24:27], s41 offen offset:0 sc1
    v_add_f32 v252, v252, v253
    s_movk_i32 s36, 0x207
    v_cmp_class_f32_e64 vcc, v252, s36
    s_nop 1
    s_cmp_lg_u64 vcc, 0
    s_cbranch_scc1 L_slow
L_end:
    s_endpgm
L_code_end:
L_slow:
    s_waitcnt vmcnt(0) lgkmcnt(0)
    s_mov_b32 s18, 262144
    s_mov_b32 s22, 262144
    v_lshrrev_b32 v12, 8, v255
    v_and_b32 v13, 0xf0, v255
    v_lshlrev_b32 v9, 4, v13
    v_lshl_add_u32 v9, v12, 4, v9
    s_add_u32 s46, s45, 0
    buffer_load_dwordx4 v[16:19], v9, s[12:15], s46 offen offset:0
    buffer_load_dwordx4 v[20:23], v9, s[12:15], s46 offen offset:64
    buffer_load_dwordx4 v[24:27], v9, s[12:15], s46 offen offset:128
    buffer_load_dwordx4 v[28:31], v9, s[12:15], s46 offen offset:192
    s_add_u32 s47, s45, 4096
    buffer_load_dwordx4 v[32:35], v9, s[12:15], s47 offen offset:0
    buffer_load_dwordx4 v[36:39], v9, s[12:15], s47 offen offset:64
    buffer_load_dwordx4 v[40:43], v9, s[12:15], s47 offen offset:128
    buffer_load_dwordx4 v[44:47], v9, s[12:15], s47 offen offset:192
    s_add_u32 s46, s45, 8192
    buffer_load_dwordx4 v[48:51], v9, s[12:15], s46 offen offset:0
    buffer_load_dwordx4 v[52:55], v9, s[12:15], s46 offen offset:64
    buffer_load_dwordx4 v[56:59], v9, s[12:15], s46 offen offset:128
    buffer_load_dwordx4 v[60:63], v9, s[12:15], s46 offen offset:192
    s_add_u32 s47, s45, 12288
    buffer_load_dwordx4 v[64:67], v9, s[12:15], s47 offen offset:0
    buffer_load_dwordx4 v[68:71], v9, s[12:15], s47 offen offset:64
    buffer_load_dwordx4 v[72:75], v9, s[12:15], s47 offen offset:128
    buffer_load_dwordx4 v[76:79], v9, s[12:15], s47 offen offset:192
    s_add_u32 s46, s45, 16384
    buffer_load_dwordx4 v[80:83], v9, s[12:15], s46 offen offset:0
    buffer_load_dwordx4 v[84:87], v9, s[12:15], s46 offen offset:64
    buffer_load_dwordx4 v[88:91], v9, s[12:15], s46 offen offset:128
    buffer_load_dwordx4 v[92:95], v9, s[12:15], s46 offen offset:192
    s_mov_b32 s47, 81920
    buffer_load_dwordx4 a[220:223], v9, s[12:15], s47 offen offset:0
    buffer_load_dwordx4 a[224:227], v9, s[12:15], s47 offen offset:64
    buffer_load_dwordx4 a[228:231], v9, s[12:15], s47 offen offset:128
    buffer_load_dwordx4 a[232:235], v9, s[12:15], s47 offen offset:192
    v_mov_b32 v192, 0xff800000
    v_mov_b32 v193, 0xff800000
    v_mov_b32 v194, 0xff800000
    v_mov_b32 v195, 0xff800000
    v_mov_b32 v196, 0xff800000
    v_mov_b32 v197, 0xff800000
    v_lshrrev_b32 v12, 8, v255
    v_and_b32 v13, 0xf0, v255
    v_lshrrev_b32 v13, 3, v13
    v_lshl_add_u32 v11, v12, 10, v13
    s_mov_b32 s36, 0
L_slow1:
    s_add_u32 s37, s36, 4096
    buffer_load_dwordx4 v[96:99], v9, s[16:19], s36 offen offset:0
    buffer_load_dwordx4 v[100:103], v9, s[16:19], s36 offen offset:64
    buffer_load_dwordx4 v[104:107], v9, s[16:19], s36 offen offset:128
    buffer_load_dwordx4 v[108:111], v9, s[16:19], s36 offen offset:192
    buffer_load_dwordx4 v[112:115], v9, s[16:19], s37 offen offset:0
    buffer_load_dwordx4 v[116:119], v9, s[16:19], s37 offen offset:64
    buffer_load_dwordx4 v[120:123], v9, s[16:19], s37 offen offset:128
    buffer_load_dwordx4 v[124:127], v9, s[16:19], s37 offen offset:192
    s_waitcnt vmcnt(0)
    v_mfma_f32_16x16x32_bf16 v[224:227], v[96:99], v[16:19], 0
    v_mfma_f32_16x16x32_bf16 v[224:227], v[100:103], v[20:23], v[224:227]
    v_mfma_f32_16x16x32_bf16 v[224:227], v[104:107], v[24:27], v[224:227]
    v_mfma_f32_16x16x32_bf16 v[224:227], v[108:111], v[28:31], v[224:227]
    v_mfma_f32_16x16x32_bf16 v[228:231], v[112:115], v[16:19], 0
    v_mfma_f32_16x16x32_bf16 v[228:231], v[116:119], v[20:23], v[228:231]
    v_mfma_f32_16x16x32_bf16 v[228:231], v[120:123], v[24:27], v[228:231]
    v_mfma_f32_16x16x32_bf16 v[228:231], v[124:127], v[28:31], v[228:231]
    s_nop 7
    s_nop 1
    v_max3_f32 v192, v224, v225, v192
    v_max3_f32 v192, v226, v227, v192
    v_max3_f32 v192, v228, v229, v192
    v_max3_f32 v192, v230, v231, v192
    v_mfma_f32_16x16x32_bf16 v[232:235], v[96:99], v[32:35], 0
    v_mfma_f32_16x16x32_bf16 v[232:235], v[100:103], v[36:39], v[232:235]
    v_mfma_f32_16x16x32_bf16 v[232:235], v[104:107], v[40:43], v[232:235]
    v_mfma_f32_16x16x32_bf16 v[232:235], v[108:111], v[44:47], v[232:235]
    v_mfma_f32_16x16x32_bf16 v[236:239], v[112:115], v[32:35], 0
    v_mfma_f32_16x16x32_bf16 v[236:239], v[116:119], v[36:39], v[236:239]
    v_mfma_f32_16x16x32_bf16 v[236:239], v[120:123], v[40:43], v[236:239]
    v_mfma_f32_16x16x32_bf16 v[236:239], v[124:127], v[44:47], v[236:239]
    s_nop 7
    s_nop 1
    v_max3_f32 v193, v232, v233, v193
    v_max3_f32 v193, v234, v235, v193
    v_max3_f32 v193, v236, v237, v193
    v_max3_f32 v193, v238, v239, v193
    v_mfma_f32_16x16x32_bf16 v[240:243], v[96:99], v[48:51], 0
    v_mfma_f32_16x16x32_bf16 v[240:243], v[100:103], v[52:55], v[240:243]
    v_mfma_f32_16x16x32_bf16 v[240:243], v[104:107], v[56:59], v[240:243]
    v_mfma_f32_16x16x32_bf16 v[240:243], v[108:111], v[60:63], v[240:243]
    v_mfma_f32_16x16x32_bf16 v[244:247], v[112:115], v[48:51], 0
    v_mfma_f32_16x16x32_bf16 v[244:247], v[116:119], v[52:55], v[244:247]
    v_mfma_f32_16x16x32_bf16 v[244:247], v[120:123], v[56:59], v[244:247]
    v_mfma_f32_16x16x32_bf16 v[244:247], v[124:127], v[60:63], v[244:247]
    s_nop 7
    s_nop 1
    v_max3_f32 v194, v240, v241, v194
    v_max3_f32 v194, v242, v243, v194
    v_max3_f32 v194, v244, v245, v194
    v_max3_f32 v194, v246, v247, v194
    v_mfma_f32_16x16x32_bf16 v[224:227], v[96:99], v[64:67], 0
    v_mfma_f32_16x16x32_bf16 v[224:227], v[100:103], v[68:71], v[224:227]
    v_mfma_f32_16x16x32_bf16 v[224:227], v[104:107], v[72:75], v[224:227]
    v_mfma_f32_16x16x32_bf16 v[224:227], v[108:111], v[76:79], v[224:227]
    v_mfma_f32_16x16x32_bf16 v[228:231], v[112:115], v[64:67], 0
    v_mfma_f32_16x16x32_bf16 v[228:231], v[116:119], v[68:71], v[228:231]
    v_mfma_f32_16x16x32_bf16 v[228:231], v[120:123], v[72:75], v[228:231]
    v_mfma_f32_16x16x32_bf16 v[228:231], v[124:127], v[76:79], v[228:231]
    s_nop 7
    s_nop 1
    v_max3_f32 v195, v224, v225, v195
    v_max3_f32 v195, v226, v227, v195
    v_max3_f32 v195, v228, v229, v195
    v_max3_f32 v195, v230, v231, v195
    v_mfma_f32_16x16x32_bf16 v[232:235], v[96:99], v[80:83], 0
    v_mfma_f32_16x16x32_bf16 v[232:235], v[100:103], v[84:87], v[232:235]
    v_mfma_f32_16x16x32_bf16 v[232:235], v[104:107], v[88:91], v[232:235]
    v_mfma_f32_16x16x32_bf16 v[232:235], v[108:111], v[92:95], v[232:235]
    v_mfma_f32_16x16x32_bf16 v[236:239], v[112:115], v[80:83], 0
    v_mfma_f32_16x16x32_bf16 v[236:239], v[116:119], v[84:87], v[236:239]
    v_mfma_f32_16x16x32_bf16 v[236:239], v[120:123], v[88:91], v[236:239]
    v_mfma_f32_16x16x32_bf16 v[236:239], v[124:127], v[92:95], v[236:239]
    s_nop 7
    s_nop 1
    v_max3_f32 v196, v232, v233, v196
    v_max3_f32 v196, v234, v235, v196
    v_max3_f32 v196, v236, v237, v196
    v_max3_f32 v196, v238, v239, v196
    v_mfma_f32_16x16x32_bf16 v[240:243], v[96:99], a[220:223], 0
    v_mfma_f32_16x16x32_bf16 v[240:243], v[100:103], a[224:227], v[240:243]
    v_mfma_f32_16x16x32_bf16 v[240:243], v[104:107], a[228:231], v[240:243]
    v_mfma_f32_16x16x32_bf16 v[240:243], v[108:111], a[232:235], v[240:243]
    v_mfma_f32_16x16x32_bf16 v[244:247], v[112:115], a[220:223], 0
    v_mfma_f32_16x16x32_bf16 v[244:247], v[116:119], a[224:227], v[244:247]
    v_mfma_f32_16x16x32_bf16 v[244:247], v[120:123], a[228:231], v[244:247]
    v_mfma_f32_16x16x32_bf16 v[244:247], v[124:127], a[232:235], v[244:247]
    s_nop 7
    s_nop 1
    v_max3_f32 v197, v240, v241, v197
    v_max3_f32 v197, v242, v243, v197
    v_max3_f32 v197, v244, v245, v197
    v_max3_f32 v197, v246, v247, v197
    s_add_u32 s36, s36, 8192
    s_cmp_lt_u32 s36, 262144
    s_cbranch_scc1 L_slow1
    v_mov_b32 v12, v192
    s_nop 1
    v_permlane16_swap_b32 v192, v12
    s_nop 1
    v_max_f32 v192, v192, v12
    v_mov_b32 v12, v192
    s_nop 1
    v_permlane32_swap_b32 v192, v12
    s_nop 1
    v_max_f32 v192, v192, v12
    v_mul_f32 v128, s34, v192
    v_mov_b32 v12, v193
    s_nop 1
    v_permlane16_swap_b32 v193, v12
    s_nop 1
    v_max_f32 v193, v193, v12
    v_mov_b32 v12, v193
    s_nop 1
    v_permlane32_swap_b32 v193, v12
    s_nop 1
    v_max_f32 v193, v193, v12
    v_mul_f32 v129, s34, v193
    v_mov_b32 v12, v194
    s_nop 1
    v_permlane16_swap_b32 v194, v12
    s_nop 1
    v_max_f32 v194, v194, v12
    v_mov_b32 v12, v194
    s_nop 1
    v_permlane32_swap_b32 v194, v12
    s_nop 1
    v_max_f32 v194, v194, v12
    v_mul_f32 v130, s34, v194
    v_mov_b32 v12, v195
    s_nop 1
    v_permlane16_swap_b32 v195, v12
    s_nop 1
    v_max_f32 v195, v195, v12
    v_mov_b32 v12, v195
    s_nop 1
    v_permlane32_swap_b32 v195, v12
    s_nop 1
    v_max_f32 v195, v195, v12
    v_mul_f32 v131, s34, v195
    v_mov_b32 v12, v196
    s_nop 1
    v_permlane16_swap_b32 v196, v12
    s_nop 1
    v_max_f32 v196, v196, v12
    v_mov_b32 v12, v196
    s_nop 1
    v_permlane32_swap_b32 v196, v12
    s_nop 1
    v_max_f32 v196, v196, v12
    v_mul_f32 v132, s34, v196
    v_mov_b32 v12, v197
    s_nop 1
    v_permlane16_swap_b32 v197, v12
    s_nop 1
    v_max_f32 v197, v197, v12
    v_mov_b32 v12, v197
    s_nop 1
    v_permlane32_swap_b32 v197, v12
    s_nop 1
    v_max_f32 v197, v197, v12
    v_mul_f32 v133, s34, v197
    v_accvgpr_write_b32 a0, 0
    v_accvgpr_write_b32 a1, 0
    v_accvgpr_write_b32 a2, 0
    v_accvgpr_write_b32 a3, 0
    v_accvgpr_write_b32 a4, 0
    v_accvgpr_write_b32 a5, 0
    v_accvgpr_write_b32 a6, 0
    v_accvgpr_write_b32 a7, 0
    v_accvgpr_write_b32 a8, 0
    v_accvgpr_write_b32 a9, 0
    v_accvgpr_write_b32 a10, 0
    v_accvgpr_write_b32 a11, 0
    v_accvgpr_write_b32 a12, 0
    v_accvgpr_write_b32 a13, 0
    v_accvgpr_write_b32 a14, 0
    v_accvgpr_write_b32 a15, 0
    v_accvgpr_write_b32 a16, 0
    v_accvgpr_write_b32 a17, 0
    v_accvgpr_write_b32 a18, 0
    v_accvgpr_write_b32 a19, 0
    v_accvgpr_write_b32 a20, 0
    v_accvgpr_write_b32 a21, 0
    v_accvgpr_write_b32 a22, 0
    v_accvgpr_write_b32 a23, 0
    v_accvgpr_write_b32 a24, 0
    v_accvgpr_write_b32 a25, 0
    v_accvgpr_write_b32 a26, 0
    v_accvgpr_write_b32 a27, 0
    v_accvgpr_write_b32 a28, 0
    v_accvgpr_write_b32 a29, 0
    v_accvgpr_write_b32 a30, 0
    v_accvgpr_write_b32 a31, 0
    v_accvgpr_write_b32 a32, 0
    v_accvgpr_write_b32 a33, 0
    v_accvgpr_write_b32 a34, 0
    v_accvgpr_write_b32 a35, 0
    v_accvgpr_write_b32 a36, 0
    v_accvgpr_write_b32 a37, 0
    v_accvgpr_write_b32 a38, 0
    v_accvgpr_write_b32 a39, 0
    v_accvgpr_write_b32 a40, 0
    v_accvgpr_write_b32 a41, 0
    v_accvgpr_write_b32 a42, 0
    v_accvgpr_write_b32 a43, 0
    v_accvgpr_write_b32 a44, 0
    v_accvgpr_write_b32 a45, 0
    v_accvgpr_write_b32 a46, 0
    v_accvgpr_write_b32 a47, 0
    v_accvgpr_write_b32 a48, 0
    v_accvgpr_write_b32 a49, 0
    v_accvgpr_write_b32 a50, 0
    v_accvgpr_write_b32 a51, 0
    v_accvgpr_write_b32 a52, 0
    v_accvgpr_write_b32 a53, 0
    v_accvgpr_write_b32 a54, 0
    v_accvgpr_write_b32 a55, 0
    v_accvgpr_write_b32 a56, 0
    v_accvgpr_write_b32 a57, 0
    v_accvgpr_write_b32 a58, 0
    v_accvgpr_write_b32 a59, 0
    v_accvgpr_write_b32 a60, 0
    v_accvgpr_write_b32 a61, 0
    v_accvgpr_write_b32 a62, 0
    v_accvgpr_write_b32 a63, 0
    v_accvgpr_write_b32 a64, 0
    v_accvgpr_write_b32 a65, 0
    v_accvgpr_write_b32 a66, 0
    v_accvgpr_write_b32 a67, 0
    v_accvgpr_write_b32 a68, 0
    v_accvgpr_write_b32 a69, 0
    v_accvgpr_write_b32 a70, 0
    v_accvgpr_write_b32 a71, 0
    v_accvgpr_write_b32 a72, 0
    v_accvgpr_write_b32 a73, 0
    v_accvgpr_write_b32 a74, 0
    v_accvgpr_write_b32 a75, 0
    v_accvgpr_write_b32 a76, 0
    v_accvgpr_write_b32 a77, 0
    v_accvgpr_write_b32 a78, 0
    v_accvgpr_write_b32 a79, 0
    v_accvgpr_write_b32 a80, 0
    v_accvgpr_write_b32 a81, 0
    v_accvgpr_write_b32 a82, 0
    v_accvgpr_write_b32 a83, 0
    v_accvgpr_write_b32 a84, 0
    v_accvgpr_write_b32 a85, 0
    v_accvgpr_write_b32 a86, 0
    v_accvgpr_write_b32 a87, 0
    v_accvgpr_write_b32 a88, 0
    v_accvgpr_write_b32 a89, 0
    v_accvgpr_write_b32 a90, 0
    v_accvgpr_write_b32 a91, 0
    v_accvgpr_write_b32 a92, 0
    v_accvgpr_write_b32 a93, 0
    v_accvgpr_write_b32 a94, 0
    v_accvgpr_write_b32 a95, 0
    v_accvgpr_write_b32 a96, 0
    v_accvgpr_write_b32 a97, 0
    v_accvgpr_write_b32 a98, 0
    v_accvgpr_write_b32 a99, 0
    v_accvgpr_write_b32 a100, 0
    v_accvgpr_write_b32 a101, 0
    v_accvgpr_write_b32 a102, 0
    v_accvgpr_write_b32 a103, 0
    v_accvgpr_write_b32 a104, 0
    v_accvgpr_write_b32 a105, 0
    v_accvgpr_write_b32 a106, 0
    v_accvgpr_write_b32 a107, 0
    v_accvgpr_write_b32 a108, 0
    v_accvgpr_write_b32 a109, 0
    v_accvgpr_write_b32 a110, 0
    v_accvgpr_write_b32 a111, 0
    v_accvgpr_write_b32 a112, 0
    v_accvgpr_write_b32 a113, 0
    v_accvgpr_write_b32 a114, 0
    v_accvgpr_write_b32 a115, 0
    v_accvgpr_write_b32 a116, 0
    v_accvgpr_write_b32 a117, 0
    v_accvgpr_write_b32 a118, 0
    v_accvgpr_write_b32 a119, 0
    v_accvgpr_write_b32 a120, 0
    v_accvgpr_write_b32 a121, 0
    v_accvgpr_write_b32 a122, 0
    v_accvgpr_write_b32 a123, 0
    v_accvgpr_write_b32 a124, 0
    v_accvgpr_write_b32 a125, 0
    v_accvgpr_write_b32 a126, 0
    v_accvgpr_write_b32 a127, 0
    v_accvgpr_write_b32 a128, 0
    v_accvgpr_write_b32 a129, 0
    v_accvgpr_write_b32 a130, 0
    v_accvgpr_write_b32 a131, 0
    v_accvgpr_write_b32 a132, 0
    v_accvgpr_write_b32 a133, 0
    v_accvgpr_write_b32 a134, 0
    v_accvgpr_write_b32 a135, 0
    v_accvgpr_write_b32 a136, 0
    v_accvgpr_write_b32 a137, 0
    v_accvgpr_write_b32 a138, 0
    v_accvgpr_write_b32 a139, 0
    v_accvgpr_write_b32 a140, 0
    v_accvgpr_write_b32 a141, 0
    v_accvgpr_write_b32 a142, 0
    v_accvgpr_write_b32 a143, 0
    v_accvgpr_write_b32 a144, 0
    v_accvgpr_write_b32 a145, 0
    v_accvgpr_write_b32 a146, 0
    v_accvgpr_write_b32 a147, 0
    v_accvgpr_write_b32 a148, 0
    v_accvgpr_write_b32 a149, 0
    v_accvgpr_write_b32 a150, 0
    v_accvgpr_write_b32 a151, 0
    v_accvgpr_write_b32 a152, 0
    v_accvgpr_write_b32 a153, 0
    v_accvgpr_write_b32 a154, 0
    v_accvgpr_write_b32 a155, 0
    v_accvgpr_write_b32 a156, 0
    v_accvgpr_write_b32 a157, 0
    v_accvgpr_write_b32 a158, 0
    v_accvgpr_write_b32 a159, 0
    v_accvgpr_write_b32 a160, 0
    v_accvgpr_write_b32 a161, 0
    v_accvgpr_write_b32 a162, 0
    v_accvgpr_write_b32 a163, 0
    v_accvgpr_write_b32 a164, 0
    v_accvgpr_write_b32 a165, 0
    v_accvgpr_write_b32 a166, 0
    v_accvgpr_write_b32 a167, 0
    v_accvgpr_write_b32 a168, 0
    v_accvgpr_write_b32 a169, 0
    v_accvgpr_write_b32 a170, 0
    v_accvgpr_write_b32 a171, 0
    v_accvgpr_write_b32 a172, 0
    v_accvgpr_write_b32 a173, 0
    v_accvgpr_write_b32 a174, 0
    v_accvgpr_write_b32 a175, 0
    v_accvgpr_write_b32 a176, 0
    v_accvgpr_write_b32 a177, 0
    v_accvgpr_write_b32 a178, 0
    v_accvgpr_write_b32 a179, 0
    v_accvgpr_write_b32 a180, 0
    v_accvgpr_write_b32 a181, 0
    v_accvgpr_write_b32 a182, 0
    v_accvgpr_write_b32 a183, 0
    v_accvgpr_write_b32 a184, 0
    v_accvgpr_write_b32 a185, 0
    v_accvgpr_write_b32 a186, 0
    v_accvgpr_write_b32 a187, 0
    v_accvgpr_write_b32 a188, 0
    v_accvgpr_write_b32 a189, 0
    v_accvgpr_write_b32 a190, 0
    v_accvgpr_write_b32 a191, 0
    v_accvgpr_write_b32 a192, 0
    v_accvgpr_write_b32 a193, 0
    v_accvgpr_write_b32 a194, 0
    v_accvgpr_write_b32 a195, 0
    v_accvgpr_write_b32 a196, 0
    v_accvgpr_write_b32 a197, 0
    v_accvgpr_write_b32 a198, 0
    v_accvgpr_write_b32 a199, 0
    v_accvgpr_write_b32 a200, 0
    v_accvgpr_write_b32 a201, 0
    v_accvgpr_write_b32 a202, 0
    v_accvgpr_write_b32 a203, 0
    v_accvgpr_write_b32 a204, 0
    v_accvgpr_write_b32 a205, 0
    v_accvgpr_write_b32 a206, 0
    v_accvgpr_write_b32 a207, 0
    v_accvgpr_write_b32 a208, 0
    v_accvgpr_write_b32 a209, 0
    v_accvgpr_write_b32 a210, 0
    v_accvgpr_write_b32 a211, 0
    v_accvgpr_write_b32 a212, 0
    v_accvgpr_write_b32 a213, 0
    v_accvgpr_write_b32 a214, 0
    v_accvgpr_write_b32 a215, 0
    s_mov_b32 s36, 0
L_slow2:
    s_add_u32 s37, s36, 4096
    buffer_load_dwordx4 v[96:99], v9, s[16:19], s36 offen offset:0
    buffer_load_dwordx4 v[100:103], v9, s[16:19], s36 offen offset:64
    buffer_load_dwordx4 v[104:107], v9, s[16:19], s36 offen offset:128
    buffer_load_dwordx4 v[108:111], v9, s[16:19], s36 offen offset:192
    buffer_load_dwordx4 v[112:115], v9, s[16:19], s37 offen offset:0
    buffer_load_dwordx4 v[116:119], v9, s[16:19], s37 offen offset:64
    buffer_load_dwordx4 v[120:123], v9, s[16:19], s37 offen offset:128
    buffer_load_dwordx4 v[124:127], v9, s[16:19], s37 offen offset:192
    buffer_load_ushort v160, v11, s[20:23], s36 offen offset:0
    buffer_load_ushort v192, v11, s[20:23], s36 offen offset:256
    buffer_load_ushort v161, v11, s[20:23], s36 offen offset:512
    buffer_load_ushort v193, v11, s[20:23], s36 offen offset:768
    buffer_load_ushort v162, v11, s[20:23], s37 offen offset:0
    buffer_load_ushort v194, v11, s[20:23], s37 offen offset:256
    buffer_load_ushort v163, v11, s[20:23], s37 offen offset:512
    buffer_load_ushort v195, v11, s[20:23], s37 offen offset:768
    buffer_load_ushort v164, v11, s[20:23], s36 offen offset:32
    buffer_load_ushort v196, v11, s[20:23], s36 offen offset:288
    buffer_load_ushort v165, v11, s[20:23], s36 offen offset:544
    buffer_load_ushort v197, v11, s[20:23], s36 offen offset:800
    buffer_load_ushort v166, v11, s[20:23], s37 offen offset:32
    buffer_load_ushort v198, v11, s[20:23], s37 offen offset:288
    buffer_load_ushort v167, v11, s[20:23], s37 offen offset:544
    buffer_load_ushort v199, v11, s[20:23], s37 offen offset:800
    buffer_load_ushort v168, v11, s[20:23], s36 offen offset:64
    buffer_load_ushort v200, v11, s[20:23], s36 offen offset:320
    buffer_load_ushort v169, v11, s[20:23], s36 offen offset:576
    buffer_load_ushort v201, v11, s[20:23], s36 offen offset:832
    buffer_load_ushort v170, v11, s[20:23], s37 offen offset:64
    buffer_load_ushort v202, v11, s[20:23], s37 offen offset:320
    buffer_load_ushort v171, v11, s[20:23], s37 offen offset:576
    buffer_load_ushort v203, v11, s[20:23], s37 offen offset:832
    buffer_load_ushort v172, v11, s[20:23], s36 offen offset:96
    buffer_load_ushort v204, v11, s[20:23], s36 offen offset:352
    buffer_load_ushort v173, v11, s[20:23], s36 offen offset:608
    buffer_load_ushort v205, v11, s[20:23], s36 offen offset:864
    buffer_load_ushort v174, v11, s[20:23], s37 offen offset:96
    buffer_load_ushort v206, v11, s[20:23], s37 offen offset:352
    buffer_load_ushort v175, v11, s[20:23], s37 offen offset:608
    buffer_load_ushort v207, v11, s[20:23], s37 offen offset:864
    s_waitcnt vmcnt(0)
    buffer_load_ushort v176, v11, s[20:23], s36 offen offset:128
    buffer_load_ushort v208, v11, s[20:23], s36 offen offset:384
    buffer_load_ushort v177, v11, s[20:23], s36 offen offset:640
    buffer_load_ushort v209, v11, s[20:23], s36 offen offset:896
    buffer_load_ushort v178, v11, s[20:23], s37 offen offset:128
    buffer_load_ushort v210, v11, s[20:23], s37 offen offset:384
    buffer_load_ushort v179, v11, s[20:23], s37 offen offset:640
    buffer_load_ushort v211, v11, s[20:23], s37 offen offset:896
    buffer_load_ushort v180, v11, s[20:23], s36 offen offset:160
    buffer_load_ushort v212, v11, s[20:23], s36 offen offset:416
    buffer_load_ushort v181, v11, s[20:23], s36 offen offset:672
    buffer_load_ushort v213, v11, s[20:23], s36 offen offset:928
    buffer_load_ushort v182, v11, s[20:23], s37 offen offset:160
    buffer_load_ushort v214, v11, s[20:23], s37 offen offset:416
    buffer_load_ushort v183, v11, s[20:23], s37 offen offset:672
    buffer_load_ushort v215, v11, s[20:23], s37 offen offset:928
    buffer_load_ushort v184, v11, s[20:23], s36 offen offset:192
    buffer_load_ushort v216, v11, s[20:23], s36 offen offset:448
    buffer_load_ushort v185, v11, s[20:23], s36 offen offset:704
    buffer_load_ushort v217, v11, s[20:23], s36 offen offset:960
    buffer_load_ushort v186, v11, s[20:23], s37 offen offset:192
    buffer_load_ushort v218, v11, s[20:23], s37 offen offset:448
    buffer_load_ushort v187, v11, s[20:23], s37 offen offset:704
    buffer_load_ushort v219, v11, s[20:23], s37 offen offset:960
    buffer_load_ushort v188, v11, s[20:23], s36 offen offset:224
    buffer_load_ushort v220, v11, s[20:23], s36 offen offset:480
    buffer_load_ushort v189, v11, s[20:23], s36 offen offset:736
    buffer_load_ushort v221, v11, s[20:23], s36 offen offset:992
    buffer_load_ushort v190, v11, s[20:23], s37 offen offset:224
    buffer_load_ushort v222, v11, s[20:23], s37 offen offset:480
    buffer_load_ushort v191, v11, s[20:23], s37 offen offset:736
    buffer_load_ushort v223, v11, s[20:23], s37 offen offset:992
    s_waitcnt vmcnt(0)
    v_lshl_or_b32 v160, v192, 16, v160
    v_lshl_or_b32 v161, v193, 16, v161
    v_lshl_or_b32 v162, v194, 16, v162
    v_lshl_or_b32 v163, v195, 16, v163
    v_lshl_or_b32 v164, v196, 16, v164
    v_lshl_or_b32 v165, v197, 16, v165
    v_lshl_or_b32 v166, v198, 16, v166
    v_lshl_or_b32 v167, v199, 16, v167
    v_lshl_or_b32 v168, v200, 16, v168
    v_lshl_or_b32 v169, v201, 16, v169
    v_lshl_or_b32 v170, v202, 16, v170
    v_lshl_or_b32 v171, v203, 16, v171
    v_lshl_or_b32 v172, v204, 16, v172
    v_lshl_or_b32 v173, v205, 16, v173
    v_lshl_or_b32 v174, v206, 16, v174
    v_lshl_or_b32 v175, v207, 16, v175
    v_lshl_or_b32 v176, v208, 16, v176
    v_lshl_or_b32 v177, v209, 16, v177
    v_lshl_or_b32 v178, v210, 16, v178
    v_lshl_or_b32 v179, v211, 16, v179
    v_lshl_or_b32 v180, v212, 16, v180
    v_lshl_or_b32 v181, v213, 16, v181
    v_lshl_or_b32 v182, v214, 16, v182
    v_lshl_or_b32 v183, v215, 16, v183
    v_lshl_or_b32 v184, v216, 16, v184
    v_lshl_or_b32 v185, v217, 16, v185
    v_lshl_or_b32 v186, v218, 16, v186
    v_lshl_or_b32 v187, v219, 16, v187
    v_lshl_or_b32 v188, v220, 16, v188
    v_lshl_or_b32 v189, v221, 16, v189
    v_lshl_or_b32 v190, v222, 16, v190
    v_lshl_or_b32 v191, v223, 16, v191
    v_mfma_f32_16x16x32_bf16 v[224:227], v[96:99], v[16:19], 0
    v_mfma_f32_16x16x32_bf16 v[224:227], v[100:103], v[20:23], v[224:227]
    v_mfma_f32_16x16x32_bf16 v[224:227], v[104:107], v[24:27], v[224:227]
    v_mfma_f32_16x16x32_bf16 v[224:227], v[108:111], v[28:31], v[224:227]
    v_mfma_f32_16x16x32_bf16 v[228:231], v[112:115], v[16:19], 0
    v_mfma_f32_16x16x32_bf16 v[228:231], v[116:119], v[20:23], v[228:231]
    v_mfma_f32_16x16x32_bf16 v[228:231], v[120:123], v[24:27], v[228:231]
    v_mfma_f32_16x16x32_bf16 v[228:231], v[124:127], v[28:31], v[228:231]
    s_nop 7
    s_nop 1
    v_fma_f32 v224, v224, s34, -v128
    v_fma_f32 v225, v225, s34, -v128
    v_fma_f32 v226, v226, s34, -v128
    v_fma_f32 v227, v227, s34, -v128
    v_fma_f32 v228, v228, s34, -v128
    v_fma_f32 v229, v229, s34, -v128
    v_fma_f32 v230, v230, s34, -v128
    v_fma_f32 v231, v231, s34, -v128
    v_exp_f32 v224, v224
    v_exp_f32 v225, v225
    v_exp_f32 v226, v226
    v_exp_f32 v227, v227
    v_exp_f32 v228, v228
    v_exp_f32 v229, v229
    v_exp_f32 v230, v230
    v_exp_f32 v231, v231
    v_cvt_pk_bf16_f32 v224, v224, v225
    v_cvt_pk_bf16_f32 v225, v226, v227
    v_cvt_pk_bf16_f32 v226, v228, v229
    v_cvt_pk_bf16_f32 v227, v230, v231
    s_nop 1
    v_mfma_f32_16x16x32_bf16 a[192:195], a[216:219], v[224:227], a[192:195]
    v_mfma_f32_16x16x32_bf16 a[0:3], v[160:163], v[224:227], a[0:3]
    v_mfma_f32_16x16x32_bf16 a[4:7], v[164:167], v[224:227], a[4:7]
    v_mfma_f32_16x16x32_bf16 a[8:11], v[168:171], v[224:227], a[8:11]
    v_mfma_f32_16x16x32_bf16 a[12:15], v[172:175], v[224:227], a[12:15]
    v_mfma_f32_16x16x32_bf16 a[16:19], v[176:179], v[224:227], a[16:19]
    v_mfma_f32_16x16x32_bf16 a[20:23], v[180:183], v[224:227], a[20:23]
    v_mfma_f32_16x16x32_bf16 a[24:27], v[184:187], v[224:227], a[24:27]
    v_mfma_f32_16x16x32_bf16 a[28:31], v[188:191], v[224:227], a[28:31]
    v_mfma_f32_16x16x32_bf16 v[232:235], v[96:99], v[32:35], 0
    v_mfma_f32_16x16x32_bf16 v[232:235], v[100:103], v[36:39], v[232:235]
    v_mfma_f32_16x16x32_bf16 v[232:235], v[104:107], v[40:43], v[232:235]
    v_mfma_f32_16x16x32_bf16 v[232:235], v[108:111], v[44:47], v[232:235]
    v_mfma_f32_16x16x32_bf16 v[236:239], v[112:115], v[32:35], 0
    v_mfma_f32_16x16x32_bf16 v[236:239], v[116:119], v[36:39], v[236:239]
    v_mfma_f32_16x16x32_bf16 v[236:239], v[120:123], v[40:43], v[236:239]
    v_mfma_f32_16x16x32_bf16 v[236:239], v[124:127], v[44:47], v[236:239]
    s_nop 7
    s_nop 1
    v_fma_f32 v232, v232, s34, -v129
    v_fma_f32 v233, v233, s34, -v129
    v_fma_f32 v234, v234, s34, -v129
    v_fma_f32 v235, v235, s34, -v129
    v_fma_f32 v236, v236, s34, -v129
    v_fma_f32 v237, v237, s34, -v129
    v_fma_f32 v238, v238, s34, -v129
    v_fma_f32 v239, v239, s34, -v129
    v_exp_f32 v232, v232
    v_exp_f32 v233, v233
    v_exp_f32 v234, v234
    v_exp_f32 v235, v235
    v_exp_f32 v236, v236
    v_exp_f32 v237, v237
    v_exp_f32 v238, v238
    v_exp_f32 v239, v239
    v_cvt_pk_bf16_f32 v232, v232, v233
    v_cvt_pk_bf16_f32 v233, v234, v235
    v_cvt_pk_bf16_f32 v234, v236, v237
    v_cvt_pk_bf16_f32 v235, v238, v239
    s_nop 1
    v_mfma_f32_16x16x32_bf16 a[196:199], a[216:219], v[232:235], a[196:199]
    v_mfma_f32_16x16x32_bf16 a[32:35], v[160:163], v[232:235], a[32:35]
    v_mfma_f32_16x16x32_bf16 a[36:39], v[164:167], v[232:235], a[36:39]
    v_mfma_f32_16x16x32_bf16 a[40:43], v[168:171], v[232:235], a[40:43]
    v_mfma_f32_16x16x32_bf16 a[44:47], v[172:175], v[232:235], a[44:47]
    v_mfma_f32_16x16x32_bf16 a[48:51], v[176:179], v[232:235], a[48:51]
    v_mfma_f32_16x16x32_bf16 a[52:55], v[180:183], v[232:235], a[52:55]
    v_mfma_f32_16x16x32_bf16 a[56:59], v[184:187], v[232:235], a[56:59]
    v_mfma_f32_16x16x32_bf16 a[60:63], v[188:191], v[232:235], a[60:63]
    v_mfma_f32_16x16x32_bf16 v[240:243], v[96:99], v[48:51], 0
    v_mfma_f32_16x16x32_bf16 v[240:243], v[100:103], v[52:55], v[240:243]
    v_mfma_f32_16x16x32_bf16 v[240:243], v[104:107], v[56:59], v[240:243]
    v_mfma_f32_16x16x32_bf16 v[240:243], v[108:111], v[60:63], v[240:243]
    v_mfma_f32_16x16x32_bf16 v[244:247], v[112:115], v[48:51], 0
    v_mfma_f32_16x16x32_bf16 v[244:247], v[116:119], v[52:55], v[244:247]
    v_mfma_f32_16x16x32_bf16 v[244:247], v[120:123], v[56:59], v[244:247]
    v_mfma_f32_16x16x32_bf16 v[244:247], v[124:127], v[60:63], v[244:247]
    s_nop 7
    s_nop 1
    v_fma_f32 v240, v240, s34, -v130
    v_fma_f32 v241, v241, s34, -v130
    v_fma_f32 v242, v242, s34, -v130
    v_fma_f32 v243, v243, s34, -v130
    v_fma_f32 v244, v244, s34, -v130
    v_fma_f32 v245, v245, s34, -v130
    v_fma_f32 v246, v246, s34, -v130
    v_fma_f32 v247, v247, s34, -v130
    v_exp_f32 v240, v240
    v_exp_f32 v241, v241
    v_exp_f32 v242, v242
    v_exp_f32 v243, v243
    v_exp_f32 v244, v244
    v_exp_f32 v245, v245
    v_exp_f32 v246, v246
    v_exp_f32 v247, v247
    v_cvt_pk_bf16_f32 v240, v240, v241
    v_cvt_pk_bf16_f32 v241, v242, v243
    v_cvt_pk_bf16_f32 v242, v244, v245
    v_cvt_pk_bf16_f32 v243, v246, v247
    s_nop 1
    v_mfma_f32_16x16x32_bf16 a[200:203], a[216:219], v[240:243], a[200:203]
    v_mfma_f32_16x16x32_bf16 a[64:67], v[160:163], v[240:243], a[64:67]
    v_mfma_f32_16x16x32_bf16 a[68:71], v[164:167], v[240:243], a[68:71]
    v_mfma_f32_16x16x32_bf16 a[72:75], v[168:171], v[240:243], a[72:75]
    v_mfma_f32_16x16x32_bf16 a[76:79], v[172:175], v[240:243], a[76:79]
    v_mfma_f32_16x16x32_bf16 a[80:83], v[176:179], v[240:243], a[80:83]
    v_mfma_f32_16x16x32_bf16 a[84:87], v[180:183], v[240:243], a[84:87]
    v_mfma_f32_16x16x32_bf16 a[88:91], v[184:187], v[240:243], a[88:91]
    v_mfma_f32_16x16x32_bf16 a[92:95], v[188:191], v[240:243], a[92:95]
    v_mfma_f32_16x16x32_bf16 v[224:227], v[96:99], v[64:67], 0
    v_mfma_f32_16x16x32_bf16 v[224:227], v[100:103], v[68:71], v[224:227]
    v_mfma_f32_16x16x32_bf16 v[224:227], v[104:107], v[72:75], v[224:227]
    v_mfma_f32_16x16x32_bf16 v[224:227], v[108:111], v[76:79], v[224:227]
    v_mfma_f32_16x16x32_bf16 v[228:231], v[112:115], v[64:67], 0
    v_mfma_f32_16x16x32_bf16 v[228:231], v[116:119], v[68:71], v[228:231]
    v_mfma_f32_16x16x32_bf16 v[228:231], v[120:123], v[72:75], v[228:231]
    v_mfma_f32_16x16x32_bf16 v[228:231], v[124:127], v[76:79], v[228:231]
    s_nop 7
    s_nop 1
    v_fma_f32 v224, v224, s34, -v131
    v_fma_f32 v225, v225, s34, -v131
    v_fma_f32 v226, v226, s34, -v131
    v_fma_f32 v227, v227, s34, -v131
    v_fma_f32 v228, v228, s34, -v131
    v_fma_f32 v229, v229, s34, -v131
    v_fma_f32 v230, v230, s34, -v131
    v_fma_f32 v231, v231, s34, -v131
    v_exp_f32 v224, v224
    v_exp_f32 v225, v225
    v_exp_f32 v226, v226
    v_exp_f32 v227, v227
    v_exp_f32 v228, v228
    v_exp_f32 v229, v229
    v_exp_f32 v230, v230
    v_exp_f32 v231, v231
    v_cvt_pk_bf16_f32 v224, v224, v225
    v_cvt_pk_bf16_f32 v225, v226, v227
    v_cvt_pk_bf16_f32 v226, v228, v229
    v_cvt_pk_bf16_f32 v227, v230, v231
    s_nop 1
    v_mfma_f32_16x16x32_bf16 a[204:207], a[216:219], v[224:227], a[204:207]
    v_mfma_f32_16x16x32_bf16 a[96:99], v[160:163], v[224:227], a[96:99]
    v_mfma_f32_16x16x32_bf16 a[100:103], v[164:167], v[224:227], a[100:103]
    v_mfma_f32_16x16x32_bf16 a[104:107], v[168:171], v[224:227], a[104:107]
    v_mfma_f32_16x16x32_bf16 a[108:111], v[172:175], v[224:227], a[108:111]
    v_mfma_f32_16x16x32_bf16 a[112:115], v[176:179], v[224:227], a[112:115]
    v_mfma_f32_16x16x32_bf16 a[116:119], v[180:183], v[224:227], a[116:119]
    v_mfma_f32_16x16x32_bf16 a[120:123], v[184:187], v[224:227], a[120:123]
    v_mfma_f32_16x16x32_bf16 a[124:127], v[188:191], v[224:227], a[124:127]
    v_mfma_f32_16x16x32_bf16 v[232:235], v[96:99], v[80:83], 0
    v_mfma_f32_16x16x32_bf16 v[232:235], v[100:103], v[84:87], v[232:235]
    v_mfma_f32_16x16x32_bf16 v[232:235], v[104:107], v[88:91], v[232:235]
    v_mfma_f32_16x16x32_bf16 v[232:235], v[108:111], v[92:95], v[232:235]
    v_mfma_f32_16x16x32_bf16 v[236:239], v[112:115], v[80:83], 0
    v_mfma_f32_16x16x32_bf16 v[236:239], v[116:119], v[84:87], v[236:239]
    v_mfma_f32_16x16x32_bf16 v[236:239], v[120:123], v[88:91], v[236:239]
    v_mfma_f32_16x16x32_bf16 v[236:239], v[124:127], v[92:95], v[236:239]
    s_nop 7
    s_nop 1
    v_fma_f32 v232, v232, s34, -v132
    v_fma_f32 v233, v233, s34, -v132
    v_fma_f32 v234, v234, s34, -v132
    v_fma_f32 v235, v235, s34, -v132
    v_fma_f32 v236, v236, s34, -v132
    v_fma_f32 v237, v237, s34, -v132
    v_fma_f32 v238, v238, s34, -v132
    v_fma_f32 v239, v239, s34, -v132
    v_exp_f32 v232, v232
    v_exp_f32 v233, v233
    v_exp_f32 v234, v234
    v_exp_f32 v235, v235
    v_exp_f32 v236, v236
    v_exp_f32 v237, v237
    v_exp_f32 v238, v238
    v_exp_f32 v239, v239
    v_cvt_pk_bf16_f32 v232, v232, v233
    v_cvt_pk_bf16_f32 v233, v234, v235
    v_cvt_pk_bf16_f32 v234, v236, v237
    v_cvt_pk_bf16_f32 v235, v238, v239
    s_nop 1
    v_mfma_f32_16x16x32_bf16 a[208:211], a[216:219], v[232:235], a[208:211]
    v_mfma_f32_16x16x32_bf16 a[128:131], v[160:163], v[232:235], a[128:131]
    v_mfma_f32_16x16x32_bf16 a[132:135], v[164:167], v[232:235], a[132:135]
    v_mfma_f32_16x16x32_bf16 a[136:139], v[168:171], v[232:235], a[136:139]
    v_mfma_f32_16x16x32_bf16 a[140:143], v[172:175], v[232:235], a[140:143]
    v_mfma_f32_16x16x32_bf16 a[144:147], v[176:179], v[232:235], a[144:147]
    v_mfma_f32_16x16x32_bf16 a[148:151], v[180:183], v[232:235], a[148:151]
    v_mfma_f32_16x16x32_bf16 a[152:155], v[184:187], v[232:235], a[152:155]
    v_mfma_f32_16x16x32_bf16 a[156:159], v[188:191], v[232:235], a[156:159]
    v_mfma_f32_16x16x32_bf16 v[240:243], v[96:99], a[220:223], 0
    v_mfma_f32_16x16x32_bf16 v[240:243], v[100:103], a[224:227], v[240:243]
    v_mfma_f32_16x16x32_bf16 v[240:243], v[104:107], a[228:231], v[240:243]
    v_mfma_f32_16x16x32_bf16 v[240:243], v[108:111], a[232:235], v[240:243]
    v_mfma_f32_16x16x32_bf16 v[244:247], v[112:115], a[220:223], 0
    v_mfma_f32_16x16x32_bf16 v[244:247], v[116:119], a[224:227], v[244:247]
    v_mfma_f32_16x16x32_bf16 v[244:247], v[120:123], a[228:231], v[244:247]
    v_mfma_f32_16x16x32_bf16 v[244:247], v[124:127], a[232:235], v[244:247]
    s_nop 7
    s_nop 1
    v_fma_f32 v240, v240, s34, -v133
    v_fma_f32 v241, v241, s34, -v133
    v_fma_f32 v242, v242, s34, -v133
    v_fma_f32 v243, v243, s34, -v133
    v_fma_f32 v244, v244, s34, -v133
    v_fma_f32 v245, v245, s34, -v133
    v_fma_f32 v246, v246, s34, -v133
    v_fma_f32 v247, v247, s34, -v133
    v_exp_f32 v240, v240
    v_exp_f32 v241, v241
    v_exp_f32 v242, v242
    v_exp_f32 v243, v243
    v_exp_f32 v244, v244
    v_exp_f32 v245, v245
    v_exp_f32 v246, v246
    v_exp_f32 v247, v247
    v_cvt_pk_bf16_f32 v240, v240, v241
    v_cvt_pk_bf16_f32 v241, v242, v243
    v_cvt_pk_bf16_f32 v242, v244, v245
    v_cvt_pk_bf16_f32 v243, v246, v247
    s_nop 1
    v_mfma_f32_16x16x32_bf16 a[212:215], a[216:219], v[240:243], a[212:215]
    v_mfma_f32_16x16x32_bf16 a[160:163], v[160:163], v[240:243], a[160:163]
    v_mfma_f32_16x16x32_bf16 a[164:167], v[164:167], v[240:243], a[164:167]
    v_mfma_f32_16x16x32_bf16 a[168:171], v[168:171], v[240:243], a[168:171]
    v_mfma_f32_16x16x32_bf16 a[172:175], v[172:175], v[240:243], a[172:175]
    v_mfma_f32_16x16x32_bf16 a[176:179], v[176:179], v[240:243], a[176:179]
    v_mfma_f32_16x16x32_bf16 a[180:183], v[180:183], v[240:243], a[180:183]
    v_mfma_f32_16x16x32_bf16 a[184:187], v[184:187], v[240:243], a[184:187]
    v_mfma_f32_16x16x32_bf16 a[188:191], v[188:191], v[240:243], a[188:191]
    s_add_u32 s36, s36, 8192
    s_cmp_lt_u32 s36, 262144
    s_cbranch_scc1 L_slow2
    s_nop 7
    v_accvgpr_read_b32 v15, a192
    v_rcp_f32 v14, v15
    v_accvgpr_read_b32 v248, a0
    v_accvgpr_read_b32 v249, a1
    v_accvgpr_read_b32 v250, a2
    v_accvgpr_read_b32 v251, a3
    s_add_u32 s4, s45, 0
    v_pk_mul_f32 v[248:249], v[248:249], v[14:15] op_sel_hi:[1,0]
    v_pk_mul_f32 v[250:251], v[250:251], v[14:15] op_sel_hi:[1,0]
    v_cvt_pk_bf16_f32 v16, v248, v249
    v_cvt_pk_bf16_f32 v17, v250, v251
    v_accvgpr_read_b32 v248, a4
    v_accvgpr_read_b32 v249, a5
    v_accvgpr_read_b32 v250, a6
    v_accvgpr_read_b32 v251, a7
    v_pk_mul_f32 v[248:249], v[248:249], v[14:15] op_sel_hi:[1,0]
    v_pk_mul_f32 v[250:251], v[250:251], v[14:15] op_sel_hi:[1,0]
    v_cvt_pk_bf16_f32 v18, v248, v249
    v_cvt_pk_bf16_f32 v19, v250, v251
    v_accvgpr_read_b32 v248, a8
    v_accvgpr_read_b32 v249, a9
    v_accvgpr_read_b32 v250, a10
    v_accvgpr_read_b32 v251, a11
    v_permlane16_swap_b32 v16, v18
    v_permlane16_swap_b32 v17, v19
    buffer_store_dwordx4 v[16:19], v10, s[24:27], s4 offen offset:0 sc1
    v_pk_mul_f32 v[248:249], v[248:249], v[14:15] op_sel_hi:[1,0]
    v_pk_mul_f32 v[250:251], v[250:251], v[14:15] op_sel_hi:[1,0]
    v_cvt_pk_bf16_f32 v20, v248, v249
    v_cvt_pk_bf16_f32 v21, v250, v251
    v_accvgpr_read_b32 v248, a12
    v_accvgpr_read_b32 v249, a13
    v_accvgpr_read_b32 v250, a14
    v_accvgpr_read_b32 v251, a15
    v_pk_mul_f32 v[248:249], v[248:249], v[14:15] op_sel_hi:[1,0]
    v_pk_mul_f32 v[250:251], v[250:251], v[14:15] op_sel_hi:[1,0]
    v_cvt_pk_bf16_f32 v22, v248, v249
    v_cvt_pk_bf16_f32 v23, v250, v251
    v_accvgpr_read_b32 v248, a16
    v_accvgpr_read_b32 v249, a17
    v_accvgpr_read_b32 v250, a18
    v_accvgpr_read_b32 v251, a19
    v_permlane16_swap_b32 v20, v22
    v_permlane16_swap_b32 v21, v23
    buffer_store_dwordx4 v[20:23], v10, s[24:27], s4 offen offset:64 sc1
    v_pk_mul_f32 v[248:249], v[248:249], v[14:15] op_sel_hi:[1,0]
    v_pk_mul_f32 v[250:251], v[250:251], v[14:15] op_sel_hi:[1,0]
    v_cvt_pk_bf16_f32 v24, v248, v249
    v_cvt_pk_bf16_f32 v25, v250, v251
    v_accvgpr_read_b32 v248, a20
    v_accvgpr_read_b32 v249, a21
    v_accvgpr_read_b32 v250, a22
    v_accvgpr_read_b32 v251, a23
    v_pk_mul_f32 v[248:249], v[248:249], v[14:15] op_sel_hi:[1,0]
    v_pk_mul_f32 v[250:251], v[250:251], v[14:15] op_sel_hi:[1,0]
    v_cvt_pk_bf16_f32 v26, v248, v249
    v_cvt_pk_bf16_f32 v27, v250, v251
    v_accvgpr_read_b32 v248, a24
    v_accvgpr_read_b32 v249, a25
    v_accvgpr_read_b32 v250, a26
    v_accvgpr_read_b32 v251, a27
    v_permlane16_swap_b32 v24, v26
    v_permlane16_swap_b32 v25, v27
    buffer_store_dwordx4 v[24:27], v10, s[24:27], s4 offen offset:128 sc1
    v_pk_mul_f32 v[248:249], v[248:249], v[14:15] op_sel_hi:[1,0]
    v_pk_mul_f32 v[250:251], v[250:251], v[14:15] op_sel_hi:[1,0]
    v_cvt_pk_bf16_f32 v28, v248, v249
    v_cvt_pk_bf16_f32 v29, v250, v251
    v_accvgpr_read_b32 v248, a28
    v_accvgpr_read_b32 v249, a29
    v_accvgpr_read_b32 v250, a30
    v_accvgpr_read_b32 v251, a31
    v_pk_mul_f32 v[248:249], v[248:249], v[14:15] op_sel_hi:[1,0]
    v_pk_mul_f32 v[250:251], v[250:251], v[14:15] op_sel_hi:[1,0]
    v_cvt_pk_bf16_f32 v30, v248, v249
    v_cvt_pk_bf16_f32 v31, v250, v251
    s_nop 1
    v_permlane16_swap_b32 v28, v30
    v_permlane16_swap_b32 v29, v31
    buffer_store_dwordx4 v[28:31], v10, s[24:27], s4 offen offset:192 sc1
    v_accvgpr_read_b32 v15, a196
    v_rcp_f32 v14, v15
    v_accvgpr_read_b32 v248, a32
    v_accvgpr_read_b32 v249, a33
    v_accvgpr_read_b32 v250, a34
    v_accvgpr_read_b32 v251, a35
    s_add_u32 s5, s45, 4096
    v_pk_mul_f32 v[248:249], v[248:249], v[14:15] op_sel_hi:[1,0]
    v_pk_mul_f32 v[250:251], v[250:251], v[14:15] op_sel_hi:[1,0]
    v_cvt_pk_bf16_f32 v32, v248, v249
    v_cvt_pk_bf16_f32 v33, v250, v251
    v_accvgpr_read_b32 v248, a36
    v_accvgpr_read_b32 v249, a37
    v_accvgpr_read_b32 v250, a38
    v_accvgpr_read_b32 v251, a39
    v_pk_mul_f32 v[248:249], v[248:249], v[14:15] op_sel_hi:[1,0]
    v_pk_mul_f32 v[250:251], v[250:251], v[14:15] op_sel_hi:[1,0]
    v_cvt_pk_bf16_f32 v34, v248, v249
    v_cvt_pk_bf16_f32 v35, v250, v251
    v_accvgpr_read_b32 v248, a40
    v_accvgpr_read_b32 v249, a41
    v_accvgpr_read_b32 v250, a42
    v_accvgpr_read_b32 v251, a43
    v_permlane16_swap_b32 v32, v34
    v_permlane16_swap_b32 v33, v35
    buffer_store_dwordx4 v[32:35], v10, s[24:27], s5 offen offset:0 sc1
    v_pk_mul_f32 v[248:249], v[248:249], v[14:15] op_sel_hi:[1,0]
    v_pk_mul_f32 v[250:251], v[250:251], v[14:15] op_sel_hi:[1,0]
    v_cvt_pk_bf16_f32 v36, v248, v249
    v_cvt_pk_bf16_f32 v37, v250, v251
    v_accvgpr_read_b32 v248, a44
    v_accvgpr_read_b32 v249, a45
    v_accvgpr_read_b32 v250, a46
    v_accvgpr_read_b32 v251, a47
    v_pk_mul_f32 v[248:249], v[248:249], v[14:15] op_sel_hi:[1,0]
    v_pk_mul_f32 v[250:251], v[250:251], v[14:15] op_sel_hi:[1,0]
    v_cvt_pk_bf16_f32 v38, v248, v249
    v_cvt_pk_bf16_f32 v39, v250, v251
    v_accvgpr_read_b32 v248, a48
    v_accvgpr_read_b32 v249, a49
    v_accvgpr_read_b32 v250, a50
    v_accvgpr_read_b32 v251, a51
    v_permlane16_swap_b32 v36, v38
    v_permlane16_swap_b32 v37, v39
    buffer_store_dwordx4 v[36:39], v10, s[24:27], s5 offen offset:64 sc1
    v_pk_mul_f32 v[248:249], v[248:249], v[14:15] op_sel_hi:[1,0]
    v_pk_mul_f32 v[250:251], v[250:251], v[14:15] op_sel_hi:[1,0]
    v_cvt_pk_bf16_f32 v40, v248, v249
    v_cvt_pk_bf16_f32 v41, v250, v251
    v_accvgpr_read_b32 v248, a52
    v_accvgpr_read_b32 v249, a53
    v_accvgpr_read_b32 v250, a54
    v_accvgpr_read_b32 v251, a55
    v_pk_mul_f32 v[248:249], v[248:249], v[14:15] op_sel_hi:[1,0]
    v_pk_mul_f32 v[250:251], v[250:251], v[14:15] op_sel_hi:[1,0]
    v_cvt_pk_bf16_f32 v42, v248, v249
    v_cvt_pk_bf16_f32 v43, v250, v251
    v_accvgpr_read_b32 v248, a56
    v_accvgpr_read_b32 v249, a57
    v_accvgpr_read_b32 v250, a58
    v_accvgpr_read_b32 v251, a59
    v_permlane16_swap_b32 v40, v42
    v_permlane16_swap_b32 v41, v43
    buffer_store_dwordx4 v[40:43], v10, s[24:27], s5 offen offset:128 sc1
    v_pk_mul_f32 v[248:249], v[248:249], v[14:15] op_sel_hi:[1,0]
    v_pk_mul_f32 v[250:251], v[250:251], v[14:15] op_sel_hi:[1,0]
    v_cvt_pk_bf16_f32 v44, v248, v249
    v_cvt_pk_bf16_f32 v45, v250, v251
    v_accvgpr_read_b32 v248, a60
    v_accvgpr_read_b32 v249, a61
    v_accvgpr_read_b32 v250, a62
    v_accvgpr_read_b32 v251, a63
    v_pk_mul_f32 v[248:249], v[248:249], v[14:15] op_sel_hi:[1,0]
    v_pk_mul_f32 v[250:251], v[250:251], v[14:15] op_sel_hi:[1,0]
    v_cvt_pk_bf16_f32 v46, v248, v249
    v_cvt_pk_bf16_f32 v47, v250, v251
    s_nop 1
    v_permlane16_swap_b32 v44, v46
    v_permlane16_swap_b32 v45, v47
    buffer_store_dwordx4 v[44:47], v10, s[24:27], s5 offen offset:192 sc1
    v_accvgpr_read_b32 v15, a200
    v_rcp_f32 v14, v15
    v_accvgpr_read_b32 v248, a64
    v_accvgpr_read_b32 v249, a65
    v_accvgpr_read_b32 v250, a66
    v_accvgpr_read_b32 v251, a67
    s_add_u32 s6, s45, 8192
    v_pk_mul_f32 v[248:249], v[248:249], v[14:15] op_sel_hi:[1,0]
    v_pk_mul_f32 v[250:251], v[250:251], v[14:15] op_sel_hi:[1,0]
    v_cvt_pk_bf16_f32 v48, v248, v249
    v_cvt_pk_bf16_f32 v49, v250, v251
    v_accvgpr_read_b32 v248, a68
    v_accvgpr_read_b32 v249, a69
    v_accvgpr_read_b32 v250, a70
    v_accvgpr_read_b32 v251, a71
    v_pk_mul_f32 v[248:249], v[248:249], v[14:15] op_sel_hi:[1,0]
    v_pk_mul_f32 v[250:251], v[250:251], v[14:15] op_sel_hi:[1,0]
    v_cvt_pk_bf16_f32 v50, v248, v249
    v_cvt_pk_bf16_f32 v51, v250, v251
    v_accvgpr_read_b32 v248, a72
    v_accvgpr_read_b32 v249, a73
    v_accvgpr_read_b32 v250, a74
    v_accvgpr_read_b32 v251, a75
    v_permlane16_swap_b32 v48, v50
    v_permlane16_swap_b32 v49, v51
    buffer_store_dwordx4 v[48:51], v10, s[24:27], s6 offen offset:0 sc1
    v_pk_mul_f32 v[248:249], v[248:249], v[14:15] op_sel_hi:[1,0]
    v_pk_mul_f32 v[250:251], v[250:251], v[14:15] op_sel_hi:[1,0]
    v_cvt_pk_bf16_f32 v52, v248, v249
    v_cvt_pk_bf16_f32 v53, v250, v251
    v_accvgpr_read_b32 v248, a76
    v_accvgpr_read_b32 v249, a77
    v_accvgpr_read_b32 v250, a78
    v_accvgpr_read_b32 v251, a79
    v_pk_mul_f32 v[248:249], v[248:249], v[14:15] op_sel_hi:[1,0]
    v_pk_mul_f32 v[250:251], v[250:251], v[14:15] op_sel_hi:[1,0]
    v_cvt_pk_bf16_f32 v54, v248, v249
    v_cvt_pk_bf16_f32 v55, v250, v251
    v_accvgpr_read_b32 v248, a80
    v_accvgpr_read_b32 v249, a81
    v_accvgpr_read_b32 v250, a82
    v_accvgpr_read_b32 v251, a83
    v_permlane16_swap_b32 v52, v54
    v_permlane16_swap_b32 v53, v55
    buffer_store_dwordx4 v[52:55], v10, s[24:27], s6 offen offset:64 sc1
    v_pk_mul_f32 v[248:249], v[248:249], v[14:15] op_sel_hi:[1,0]
    v_pk_mul_f32 v[250:251], v[250:251], v[14:15] op_sel_hi:[1,0]
    v_cvt_pk_bf16_f32 v56, v248, v249
    v_cvt_pk_bf16_f32 v57, v250, v251
    v_accvgpr_read_b32 v248, a84
    v_accvgpr_read_b32 v249, a85
    v_accvgpr_read_b32 v250, a86
    v_accvgpr_read_b32 v251, a87
    v_pk_mul_f32 v[248:249], v[248:249], v[14:15] op_sel_hi:[1,0]
    v_pk_mul_f32 v[250:251], v[250:251], v[14:15] op_sel_hi:[1,0]
    v_cvt_pk_bf16_f32 v58, v248, v249
    v_cvt_pk_bf16_f32 v59, v250, v251
    v_accvgpr_read_b32 v248, a88
    v_accvgpr_read_b32 v249, a89
    v_accvgpr_read_b32 v250, a90
    v_accvgpr_read_b32 v251, a91
    v_permlane16_swap_b32 v56, v58
    v_permlane16_swap_b32 v57, v59
    buffer_store_dwordx4 v[56:59], v10, s[24:27], s6 offen offset:128 sc1
    v_pk_mul_f32 v[248:249], v[248:249], v[14:15] op_sel_hi:[1,0]
    v_pk_mul_f32 v[250:251], v[250:251], v[14:15] op_sel_hi:[1,0]
    v_cvt_pk_bf16_f32 v60, v248, v249
    v_cvt_pk_bf16_f32 v61, v250, v251
    v_accvgpr_read_b32 v248, a92
    v_accvgpr_read_b32 v249, a93
    v_accvgpr_read_b32 v250, a94
    v_accvgpr_read_b32 v251, a95
    v_pk_mul_f32 v[248:249], v[248:249], v[14:15] op_sel_hi:[1,0]
    v_pk_mul_f32 v[250:251], v[250:251], v[14:15] op_sel_hi:[1,0]
    v_cvt_pk_bf16_f32 v62, v248, v249
    v_cvt_pk_bf16_f32 v63, v250, v251
    s_nop 1
    v_permlane16_swap_b32 v60, v62
    v_permlane16_swap_b32 v61, v63
    buffer_store_dwordx4 v[60:63], v10, s[24:27], s6 offen offset:192 sc1
    v_accvgpr_read_b32 v15, a204
    v_rcp_f32 v14, v15
    v_accvgpr_read_b32 v248, a96
    v_accvgpr_read_b32 v249, a97
    v_accvgpr_read_b32 v250, a98
    v_accvgpr_read_b32 v251, a99
    s_add_u32 s7, s45, 12288
    v_pk_mul_f32 v[248:249], v[248:249], v[14:15] op_sel_hi:[1,0]
    v_pk_mul_f32 v[250:251], v[250:251], v[14:15] op_sel_hi:[1,0]
    v_cvt_pk_bf16_f32 v64, v248, v249
    v_cvt_pk_bf16_f32 v65, v250, v251
    v_accvgpr_read_b32 v248, a100
    v_accvgpr_read_b32 v249, a101
    v_accvgpr_read_b32 v250, a102
    v_accvgpr_read_b32 v251, a103
    v_pk_mul_f32 v[248:249], v[248:249], v[14:15] op_sel_hi:[1,0]
    v_pk_mul_f32 v[250:251], v[250:251], v[14:15] op_sel_hi:[1,0]
    v_cvt_pk_bf16_f32 v66, v248, v249
    v_cvt_pk_bf16_f32 v67, v250, v251
    v_accvgpr_read_b32 v248, a104
    v_accvgpr_read_b32 v249, a105
    v_accvgpr_read_b32 v250, a106
    v_accvgpr_read_b32 v251, a107
    v_permlane16_swap_b32 v64, v66
    v_permlane16_swap_b32 v65, v67
    buffer_store_dwordx4 v[64:67], v10, s[24:27], s7 offen offset:0 sc1
    v_pk_mul_f32 v[248:249], v[248:249], v[14:15] op_sel_hi:[1,0]
    v_pk_mul_f32 v[250:251], v[250:251], v[14:15] op_sel_hi:[1,0]
    v_cvt_pk_bf16_f32 v68, v248, v249
    v_cvt_pk_bf16_f32 v69, v250, v251
    v_accvgpr_read_b32 v248, a108
    v_accvgpr_read_b32 v249, a109
    v_accvgpr_read_b32 v250, a110
    v_accvgpr_read_b32 v251, a111
    v_pk_mul_f32 v[248:249], v[248:249], v[14:15] op_sel_hi:[1,0]
    v_pk_mul_f32 v[250:251], v[250:251], v[14:15] op_sel_hi:[1,0]
    v_cvt_pk_bf16_f32 v70, v248, v249
    v_cvt_pk_bf16_f32 v71, v250, v251
    v_accvgpr_read_b32 v248, a112
    v_accvgpr_read_b32 v249, a113
    v_accvgpr_read_b32 v250, a114
    v_accvgpr_read_b32 v251, a115
    v_permlane16_swap_b32 v68, v70
    v_permlane16_swap_b32 v69, v71
    buffer_store_dwordx4 v[68:71], v10, s[24:27], s7 offen offset:64 sc1
    v_pk_mul_f32 v[248:249], v[248:249], v[14:15] op_sel_hi:[1,0]
    v_pk_mul_f32 v[250:251], v[250:251], v[14:15] op_sel_hi:[1,0]
    v_cvt_pk_bf16_f32 v72, v248, v249
    v_cvt_pk_bf16_f32 v73, v250, v251
    v_accvgpr_read_b32 v248, a116
    v_accvgpr_read_b32 v249, a117
    v_accvgpr_read_b32 v250, a118
    v_accvgpr_read_b32 v251, a119
    v_pk_mul_f32 v[248:249], v[248:249], v[14:15] op_sel_hi:[1,0]
    v_pk_mul_f32 v[250:251], v[250:251], v[14:15] op_sel_hi:[1,0]
    v_cvt_pk_bf16_f32 v74, v248, v249
    v_cvt_pk_bf16_f32 v75, v250, v251
    v_accvgpr_read_b32 v248, a120
    v_accvgpr_read_b32 v249, a121
    v_accvgpr_read_b32 v250, a122
    v_accvgpr_read_b32 v251, a123
    v_permlane16_swap_b32 v72, v74
    v_permlane16_swap_b32 v73, v75
    buffer_store_dwordx4 v[72:75], v10, s[24:27], s7 offen offset:128 sc1
    v_pk_mul_f32 v[248:249], v[248:249], v[14:15] op_sel_hi:[1,0]
    v_pk_mul_f32 v[250:251], v[250:251], v[14:15] op_sel_hi:[1,0]
    v_cvt_pk_bf16_f32 v76, v248, v249
    v_cvt_pk_bf16_f32 v77, v250, v251
    v_accvgpr_read_b32 v248, a124
    v_accvgpr_read_b32 v249, a125
    v_accvgpr_read_b32 v250, a126
    v_accvgpr_read_b32 v251, a127
    v_pk_mul_f32 v[248:249], v[248:249], v[14:15] op_sel_hi:[1,0]
    v_pk_mul_f32 v[250:251], v[250:251], v[14:15] op_sel_hi:[1,0]
    v_cvt_pk_bf16_f32 v78, v248, v249
    v_cvt_pk_bf16_f32 v79, v250, v251
    s_nop 1
    v_permlane16_swap_b32 v76, v78
    v_permlane16_swap_b32 v77, v79
    buffer_store_dwordx4 v[76:79], v10, s[24:27], s7 offen offset:192 sc1
    v_accvgpr_read_b32 v15, a208
    v_rcp_f32 v14, v15
    v_accvgpr_read_b32 v248, a128
    v_accvgpr_read_b32 v249, a129
    v_accvgpr_read_b32 v250, a130
    v_accvgpr_read_b32 v251, a131
    s_add_u32 s8, s45, 16384
    v_pk_mul_f32 v[248:249], v[248:249], v[14:15] op_sel_hi:[1,0]
    v_pk_mul_f32 v[250:251], v[250:251], v[14:15] op_sel_hi:[1,0]
    v_cvt_pk_bf16_f32 v80, v248, v249
    v_cvt_pk_bf16_f32 v81, v250, v251
    v_accvgpr_read_b32 v248, a132
    v_accvgpr_read_b32 v249, a133
    v_accvgpr_read_b32 v250, a134
    v_accvgpr_read_b32 v251, a135
    v_pk_mul_f32 v[248:249], v[248:249], v[14:15] op_sel_hi:[1,0]
    v_pk_mul_f32 v[250:251], v[250:251], v[14:15] op_sel_hi:[1,0]
    v_cvt_pk_bf16_f32 v82, v248, v249
    v_cvt_pk_bf16_f32 v83, v250, v251
    v_accvgpr_read_b32 v248, a136
    v_accvgpr_read_b32 v249, a137
    v_accvgpr_read_b32 v250, a138
    v_accvgpr_read_b32 v251, a139
    v_permlane16_swap_b32 v80, v82
    v_permlane16_swap_b32 v81, v83
    buffer_store_dwordx4 v[80:83], v10, s[24:27], s8 offen offset:0 sc1
    v_pk_mul_f32 v[248:249], v[248:249], v[14:15] op_sel_hi:[1,0]
    v_pk_mul_f32 v[250:251], v[250:251], v[14:15] op_sel_hi:[1,0]
    v_cvt_pk_bf16_f32 v84, v248, v249
    v_cvt_pk_bf16_f32 v85, v250, v251
    v_accvgpr_read_b32 v248, a140
    v_accvgpr_read_b32 v249, a141
    v_accvgpr_read_b32 v250, a142
    v_accvgpr_read_b32 v251, a143
    v_pk_mul_f32 v[248:249], v[248:249], v[14:15] op_sel_hi:[1,0]
    v_pk_mul_f32 v[250:251], v[250:251], v[14:15] op_sel_hi:[1,0]
    v_cvt_pk_bf16_f32 v86, v248, v249
    v_cvt_pk_bf16_f32 v87, v250, v251
    v_accvgpr_read_b32 v248, a144
    v_accvgpr_read_b32 v249, a145
    v_accvgpr_read_b32 v250, a146
    v_accvgpr_read_b32 v251, a147
    v_permlane16_swap_b32 v84, v86
    v_permlane16_swap_b32 v85, v87
    buffer_store_dwordx4 v[84:87], v10, s[24:27], s8 offen offset:64 sc1
    v_pk_mul_f32 v[248:249], v[248:249], v[14:15] op_sel_hi:[1,0]
    v_pk_mul_f32 v[250:251], v[250:251], v[14:15] op_sel_hi:[1,0]
    v_cvt_pk_bf16_f32 v88, v248, v249
    v_cvt_pk_bf16_f32 v89, v250, v251
    v_accvgpr_read_b32 v248, a148
    v_accvgpr_read_b32 v249, a149
    v_accvgpr_read_b32 v250, a150
    v_accvgpr_read_b32 v251, a151
    v_pk_mul_f32 v[248:249], v[248:249], v[14:15] op_sel_hi:[1,0]
    v_pk_mul_f32 v[250:251], v[250:251], v[14:15] op_sel_hi:[1,0]
    v_cvt_pk_bf16_f32 v90, v248, v249
    v_cvt_pk_bf16_f32 v91, v250, v251
    v_accvgpr_read_b32 v248, a152
    v_accvgpr_read_b32 v249, a153
    v_accvgpr_read_b32 v250, a154
    v_accvgpr_read_b32 v251, a155
    v_permlane16_swap_b32 v88, v90
    v_permlane16_swap_b32 v89, v91
    buffer_store_dwordx4 v[88:91], v10, s[24:27], s8 offen offset:128 sc1
    v_pk_mul_f32 v[248:249], v[248:249], v[14:15] op_sel_hi:[1,0]
    v_pk_mul_f32 v[250:251], v[250:251], v[14:15] op_sel_hi:[1,0]
    v_cvt_pk_bf16_f32 v92, v248, v249
    v_cvt_pk_bf16_f32 v93, v250, v251
    v_accvgpr_read_b32 v248, a156
    v_accvgpr_read_b32 v249, a157
    v_accvgpr_read_b32 v250, a158
    v_accvgpr_read_b32 v251, a159
    v_pk_mul_f32 v[248:249], v[248:249], v[14:15] op_sel_hi:[1,0]
    v_pk_mul_f32 v[250:251], v[250:251], v[14:15] op_sel_hi:[1,0]
    v_cvt_pk_bf16_f32 v94, v248, v249
    v_cvt_pk_bf16_f32 v95, v250, v251
    s_nop 1
    v_permlane16_swap_b32 v92, v94
    v_permlane16_swap_b32 v93, v95
    buffer_store_dwordx4 v[92:95], v10, s[24:27], s8 offen offset:192 sc1
    v_accvgpr_read_b32 v15, a212
    v_rcp_f32 v14, v15
    v_accvgpr_read_b32 v248, a160
    v_accvgpr_read_b32 v249, a161
    v_accvgpr_read_b32 v250, a162
    v_accvgpr_read_b32 v251, a163
    s_mov_b32 s9, 81920
    v_pk_mul_f32 v[248:249], v[248:249], v[14:15] op_sel_hi:[1,0]
    v_pk_mul_f32 v[250:251], v[250:251], v[14:15] op_sel_hi:[1,0]
    v_cvt_pk_bf16_f32 v96, v248, v249
    v_cvt_pk_bf16_f32 v97, v250, v251
    v_accvgpr_read_b32 v248, a164
    v_accvgpr_read_b32 v249, a165
    v_accvgpr_read_b32 v250, a166
    v_accvgpr_read_b32 v251, a167
    v_pk_mul_f32 v[248:249], v[248:249], v[14:15] op_sel_hi:[1,0]
    v_pk_mul_f32 v[250:251], v[250:251], v[14:15] op_sel_hi:[1,0]
    v_cvt_pk_bf16_f32 v98, v248, v249
    v_cvt_pk_bf16_f32 v99, v250, v251
    v_accvgpr_read_b32 v248, a168
    v_accvgpr_read_b32 v249, a169
    v_accvgpr_read_b32 v250, a170
    v_accvgpr_read_b32 v251, a171
    v_permlane16_swap_b32 v96, v98
    v_permlane16_swap_b32 v97, v99
    buffer_store_dwordx4 v[96:99], v10, s[24:27], s9 offen offset:0 sc1
    v_pk_mul_f32 v[248:249], v[248:249], v[14:15] op_sel_hi:[1,0]
    v_pk_mul_f32 v[250:251], v[250:251], v[14:15] op_sel_hi:[1,0]
    v_cvt_pk_bf16_f32 v100, v248, v249
    v_cvt_pk_bf16_f32 v101, v250, v251
    v_accvgpr_read_b32 v248, a172
    v_accvgpr_read_b32 v249, a173
    v_accvgpr_read_b32 v250, a174
    v_accvgpr_read_b32 v251, a175
    v_pk_mul_f32 v[248:249], v[248:249], v[14:15] op_sel_hi:[1,0]
    v_pk_mul_f32 v[250:251], v[250:251], v[14:15] op_sel_hi:[1,0]
    v_cvt_pk_bf16_f32 v102, v248, v249
    v_cvt_pk_bf16_f32 v103, v250, v251
    v_accvgpr_read_b32 v248, a176
    v_accvgpr_read_b32 v249, a177
    v_accvgpr_read_b32 v250, a178
    v_accvgpr_read_b32 v251, a179
    v_permlane16_swap_b32 v100, v102
    v_permlane16_swap_b32 v101, v103
    buffer_store_dwordx4 v[100:103], v10, s[24:27], s9 offen offset:64 sc1
    v_pk_mul_f32 v[248:249], v[248:249], v[14:15] op_sel_hi:[1,0]
    v_pk_mul_f32 v[250:251], v[250:251], v[14:15] op_sel_hi:[1,0]
    v_cvt_pk_bf16_f32 v104, v248, v249
    v_cvt_pk_bf16_f32 v105, v250, v251
    v_accvgpr_read_b32 v248, a180
    v_accvgpr_read_b32 v249, a181
    v_accvgpr_read_b32 v250, a182
    v_accvgpr_read_b32 v251, a183
    v_pk_mul_f32 v[248:249], v[248:249], v[14:15] op_sel_hi:[1,0]
    v_pk_mul_f32 v[250:251], v[250:251], v[14:15] op_sel_hi:[1,0]
    v_cvt_pk_bf16_f32 v106, v248, v249
    v_cvt_pk_bf16_f32 v107, v250, v251
    v_accvgpr_read_b32 v248, a184
    v_accvgpr_read_b32 v249, a185
    v_accvgpr_read_b32 v250, a186
    v_accvgpr_read_b32 v251, a187
    v_permlane16_swap_b32 v104, v106
    v_permlane16_swap_b32 v105, v107
    buffer_store_dwordx4 v[104:107], v10, s[24:27], s9 offen offset:128 sc1
    v_pk_mul_f32 v[248:249], v[248:249], v[14:15] op_sel_hi:[1,0]
    v_pk_mul_f32 v[250:251], v[250:251], v[14:15] op_sel_hi:[1,0]
    v_cvt_pk_bf16_f32 v108, v248, v249
    v_cvt_pk_bf16_f32 v109, v250, v251
    v_accvgpr_read_b32 v248, a188
    v_accvgpr_read_b32 v249, a189
    v_accvgpr_read_b32 v250, a190
    v_accvgpr_read_b32 v251, a191
    v_pk_mul_f32 v[248:249], v[248:249], v[14:15] op_sel_hi:[1,0]
    v_pk_mul_f32 v[250:251], v[250:251], v[14:15] op_sel_hi:[1,0]
    v_cvt_pk_bf16_f32 v110, v248, v249
    v_cvt_pk_bf16_f32 v111, v250, v251
    s_nop 1
    v_permlane16_swap_b32 v108, v110
    v_permlane16_swap_b32 v109, v111
    buffer_store_dwordx4 v[108:111], v10, s[24:27], s9 offen offset:192 sc1
    s_endpgm
.section .rodata,"a"
.p2align 6
.amdhsa_kernel standalone__gqa_softmax__near_ridge_kernel
  .amdhsa_next_free_vgpr 512
  .amdhsa_next_free_sgpr 96
  .amdhsa_accum_offset 256
  .amdhsa_group_segment_fixed_size 0
  .amdhsa_kernarg_size 48
  .amdhsa_user_sgpr_count 2
  .amdhsa_user_sgpr_kernarg_segment_ptr 1
  .amdhsa_system_sgpr_workgroup_id_x 1
.end_amdhsa_kernel
```
